```python
import torch

def _softmax(x, axis=-1):
    return torch.softmax(x, dim=axis)
def _gelu(x):
    return torch.nn.functional.gelu(x, approximate="tanh")
def _silu(x):
    return torch.nn.functional.silu(x)
def _sigmoid(x):
    return torch.sigmoid(x)
def _layernorm(x, axis=-1, eps=1e-5):
    m = x.mean(dim=axis, keepdim=True)
    v = x.var(dim=axis, keepdim=True, unbiased=False)
    return (x - m) / torch.sqrt(v + eps)
def _scatter_add(tgt, idx, src, axis=0):
    return tgt.clone().index_add_(axis, idx, src)
def _segment_sum(src, seg, n):
    out = torch.zeros((n,) + src.shape[1:], dtype=src.dtype)
    return out.index_add_(0, seg, src)
def _pad(x, pw):
    flat = tuple(v for pair in reversed(pw) for v in pair)
    return torch.nn.functional.pad(x, flat)

kernel_name = 'sequential_preLN__softmax_full_mha__glu_gated_swiglu__prompt'

def setup_inputs():

    _w = (lambda a: (lambda t: t.to(torch.bfloat16) if t.is_floating_point() else t)(torch.as_tensor(a)))
    def _A_setup():
        B, S, D = 1, 2048, 512
        return {
            "x": _w((lambda *s: torch.randn(*s, dtype=torch.bfloat16) * 0.05)(B, S, D)),
            "wqkv": _w((lambda *s: torch.randn(*s, dtype=torch.bfloat16) * 0.05)(D, 3 * D)),
            "wo": _w((lambda *s: torch.randn(*s, dtype=torch.bfloat16) * 0.05)(D, D)),
        }
    _A_in = _A_setup()

    def _B_setup():
        B, S, D, F = 1, 2048, 512, 1792
        return {
            "x": _w((lambda *s: torch.randn(*s, dtype=torch.bfloat16) * 0.05)(B, S, D)),
            "w1": _w((lambda *s: torch.randn(*s, dtype=torch.bfloat16) * 0.4)(D, F) * (2.0 / D) ** 0.5),
            "w3": _w((lambda *s: torch.randn(*s, dtype=torch.bfloat16) * 0.4)(D, F) * (2.0 / D) ** 0.5),
            "w2": _w((lambda *s: torch.randn(*s, dtype=torch.bfloat16) * 0.4)(F, D) * (2.0 / F) ** 0.5),
        }
    _B_in = _B_setup()

    return {
        "A_x": _A_in["x"],
        "A_wqkv": _A_in["wqkv"],
        "A_wo": _A_in["wo"],
        "B_x": _B_in["x"],
        "B_w1": _B_in["w1"],
        "B_w3": _B_in["w3"],
        "B_w2": _B_in["w2"],
    }

def reference(A_x, A_wqkv, A_wo, B_x, B_w1, B_w3, B_w2):
    def _A_ref(x, wqkv, wo):
        B, S, D = x.shape
        H = 32; Dh = D // H
        qkv = (lambda x, *d: x.permute(*d))((x @ wqkv).reshape(B, S, 3, H, Dh), 2, 0, 3, 1, 4)
        q, k, v = qkv[0], qkv[1], qkv[2]
        scale = Dh ** -0.5
        scores = torch.einsum("bhqd,bhkd->bhqk", q, k) * scale
        p = _softmax(scores, axis=-1)
        o = torch.einsum("bhqk,bhkd->bhqd", p, v)
        return (lambda x, *d: x.permute(*d))(o, 0, 2, 1, 3).reshape(B, S, D) @ wo

    def _B_ref(x, w1, w3, w2):
        gate = torch.einsum("bsd,df->bsf", x, w1)
        up = torch.einsum("bsd,df->bsf", x, w3)
        h = _silu(gate) * up
        out = torch.einsum("bsf,fd->bsd", h, w2)
        return out

    x = A_x
    h = x + _A_ref(_layernorm(x, axis=-1), A_wqkv, A_wo)
    h2 = h + _B_ref(_layernorm(h, axis=-1), B_w1, B_w3, B_w2)
    return h2
```

```asm
; @launch kernel=kz_kernel grid=(256,1,1) block=(512,1,1) lds=163840
.amdgcn_target "amdgcn-amd-amdhsa--gfx950"
.text
.globl kz_kernel
.p2align 8
.type kz_kernel,@function
kz_kernel:
  s_cmp_ge_u32 s2, 256
  s_cbranch_scc1 kz_kernel_exit
  s_load_dwordx2 s[12:13], s[0:1], 0
  s_load_dwordx2 s[8:9], s[0:1], 72
  s_load_dwordx2 s[16:17], s[0:1], 8
  s_load_dwordx2 s[20:21], s[0:1], 64
  v_lshrrev_b32 v1, 6, v0
  s_nop 0
  v_readfirstlane_b32 s3, v1
  v_and_b32 v1, 63, v0
  s_mov_b32 s14, 0x200000
  s_mov_b32 s15, 0x00020000
  s_mov_b32 s10, 0x10000000
  s_mov_b32 s11, 0x00020000
  s_mov_b32 s18, 0x180000
  s_mov_b32 s19, 0x00020000
  s_mov_b32 s22, 0x100
  s_mov_b32 s23, 0x00020000
  s_and_b32 s4, s2, 7
  s_lshr_b32 s5, s2, 3
  s_lshr_b32 s6, s5, 2
  s_and_b32 s7, s5, 3
  s_lshl_b32 s32, s4, 2
  s_add_u32 s32, s32, s7
  s_lshl_b32 s52, s4, 1
  s_and_b32 s53, s7, 0
  s_xor_b32 s52, s52, s53
  s_mov_b32 s60, 20000
  s_movk_i32 s34, 0xc00
  s_cmp_ge_u32 s3, 4
  s_cbranch_scc1 HELP_kz_ker_1
  v_lshrrev_b32 v2, 3, v1
  v_and_b32 v3, 7, v1
  v_lshlrev_b32 v4, 10, v2
  v_lshl_add_u32 v4, v3, 4, v4
  s_lshl_b32 s53, s52, 6
  v_xor_b32 v4, s53, v4
  s_lshl_b32 s33, s32, 3
  s_add_u32 s33, s33, s3
  s_lshl_b32 s33, s33, 13
  s_add_u32 s35, s33, 0x8000
  v_xor_b32 v65, 0x80, v4
  v_xor_b32 v66, 0x100, v4
  v_xor_b32 v67, 0x180, v4
  v_xor_b32 v68, 0x200, v4
  v_xor_b32 v69, 0x280, v4
  v_xor_b32 v70, 0x300, v4
  v_xor_b32 v71, 0x380, v4
  s_waitcnt lgkmcnt(0)
  buffer_load_dwordx4 v[32:35], v4, s[12:15], s33 offen
  buffer_load_dwordx4 v[36:39], v65, s[12:15], s33 offen
  buffer_load_dwordx4 v[40:43], v66, s[12:15], s33 offen
  buffer_load_dwordx4 v[44:47], v67, s[12:15], s33 offen
  buffer_load_dwordx4 v[48:51], v68, s[12:15], s33 offen
  buffer_load_dwordx4 v[52:55], v69, s[12:15], s33 offen
  buffer_load_dwordx4 v[56:59], v70, s[12:15], s33 offen
  buffer_load_dwordx4 v[60:63], v71, s[12:15], s33 offen
  buffer_load_dwordx4 v[208:211], v4, s[12:15], s35 offen
  buffer_load_dwordx4 v[212:215], v65, s[12:15], s35 offen
  buffer_load_dwordx4 v[216:219], v66, s[12:15], s35 offen
  buffer_load_dwordx4 v[220:223], v67, s[12:15], s35 offen
  buffer_load_dwordx4 v[224:227], v68, s[12:15], s35 offen
  buffer_load_dwordx4 v[228:231], v69, s[12:15], s35 offen
  buffer_load_dwordx4 v[232:235], v70, s[12:15], s35 offen
  buffer_load_dwordx4 v[236:239], v71, s[12:15], s35 offen
  v_min_u32 v9, 47, v1
  v_mul_u32_u24 v7, 0x5556, v9
  v_lshrrev_b32 v7, 16, v7
  v_mul_u32_u24 v10, 3, v7
  v_sub_u32 v9, v9, v10
  s_lshl_b32 s38, s7, 2
  s_add_u32 s38, s38, s3
  s_mul_i32 s38, s38, 16
  s_add_u32 s38, s38, 256
  v_add_u32 v7, s38, v7
  s_lshl_b32 s38, s52, 5
  v_xor_b32 v7, s38, v7
  v_mul_u32_u24 v7, s34, v7
  v_lshl_add_u32 v7, v9, 10, v7
  s_lshl_b32 s39, s6, 7
  s_barrier
  buffer_load_dword v200, v7, s[16:19], s39 offen
  s_lshl_b32 s38, s3, 7
  s_add_u32 s38, s38, 86016
  s_movk_i32 s39, 528
  v_mul_u32_u24 v7, s39, v3
  v_lshl_add_u32 v7, v2, 4, v7
  v_add_u32 v7, s38, v7
  s_lshl_b32 s38, s3, 5
  s_add_u32 s38, s38, 158208
  v_lshl_add_u32 v8, v2, 2, s38
  s_mov_b32 s40, 0x3f803f80
  s_mov_b32 s41, 0x00003f80
  s_mov_b32 s42, 0x3f800000
  v_mov_b32 v100, 0
  v_mov_b32 v101, 0
  v_mov_b32 v102, 0
  v_mov_b32 v103, 0
  v_mov_b32 v16, 0
  v_mov_b32 v17, 0
  v_mov_b32 v18, 0
  v_mov_b32 v19, 0
  s_waitcnt vmcnt(16)
  v_dot2c_f32_bf16 v16, s40, v32
  v_dot2c_f32_bf16 v17, s40, v33
  v_dot2c_f32_bf16 v18, s40, v34
  v_dot2c_f32_bf16 v19, s40, v35
  s_waitcnt vmcnt(15)
  v_dot2c_f32_bf16 v16, s40, v36
  v_dot2c_f32_bf16 v17, s40, v37
  v_dot2c_f32_bf16 v18, s40, v38
  v_dot2c_f32_bf16 v19, s40, v39
  s_waitcnt vmcnt(14)
  v_dot2c_f32_bf16 v16, s40, v40
  v_dot2c_f32_bf16 v17, s40, v41
  v_dot2c_f32_bf16 v18, s40, v42
  v_dot2c_f32_bf16 v19, s40, v43
  s_waitcnt vmcnt(13)
  v_dot2c_f32_bf16 v16, s40, v44
  v_dot2c_f32_bf16 v17, s40, v45
  v_dot2c_f32_bf16 v18, s40, v46
  v_dot2c_f32_bf16 v19, s40, v47
  s_waitcnt vmcnt(12)
  v_dot2c_f32_bf16 v16, s40, v48
  v_dot2c_f32_bf16 v17, s40, v49
  v_dot2c_f32_bf16 v18, s40, v50
  v_dot2c_f32_bf16 v19, s40, v51
  s_waitcnt vmcnt(11)
  v_dot2c_f32_bf16 v16, s40, v52
  v_dot2c_f32_bf16 v17, s40, v53
  v_dot2c_f32_bf16 v18, s40, v54
  v_dot2c_f32_bf16 v19, s40, v55
  s_waitcnt vmcnt(10)
  v_dot2c_f32_bf16 v16, s40, v56
  v_dot2c_f32_bf16 v17, s40, v57
  v_dot2c_f32_bf16 v18, s40, v58
  v_dot2c_f32_bf16 v19, s40, v59
  s_waitcnt vmcnt(9)
  v_dot2c_f32_bf16 v16, s40, v60
  v_dot2c_f32_bf16 v17, s40, v61
  v_dot2c_f32_bf16 v18, s40, v62
  v_dot2c_f32_bf16 v19, s40, v63
  s_nop 0
  v_add_f32 v16, v16, v17
  s_nop 0
  v_add_f32 v18, v18, v19
  v_add_f32 v16, v16, v18
  s_nop 1
  v_add_f32 v16, v16, v16 quad_perm:[1,0,3,2] row_mask:0xf bank_mask:0xf
  s_nop 1
  v_add_f32 v16, v16, v16 quad_perm:[2,3,0,1] row_mask:0xf bank_mask:0xf
  s_nop 1
  v_add_f32 v16, v16, v16 row_half_mirror row_mask:0xf bank_mask:0xf
  v_mul_f32 v16, 0xbb000000, v16
  v_cvt_pk_bf16_f32 v16, v16, v16
  v_and_b32 v16, 0xffff0000, v16
  v_dot2_f32_bf16 v80, v32, s41, v16
  v_dot2_f32_bf16 v81, v32, s42, v16
  v_dot2_f32_bf16 v82, v33, s41, v16
  v_dot2_f32_bf16 v83, v33, s42, v16
  v_dot2_f32_bf16 v84, v34, s41, v16
  v_dot2_f32_bf16 v85, v34, s42, v16
  v_dot2_f32_bf16 v86, v35, s41, v16
  v_dot2_f32_bf16 v87, v35, s42, v16
  v_dot2_f32_bf16 v88, v36, s41, v16
  v_dot2_f32_bf16 v89, v36, s42, v16
  v_dot2_f32_bf16 v90, v37, s41, v16
  v_dot2_f32_bf16 v91, v37, s42, v16
  v_dot2_f32_bf16 v92, v38, s41, v16
  v_dot2_f32_bf16 v93, v38, s42, v16
  v_dot2_f32_bf16 v94, v39, s41, v16
  v_dot2_f32_bf16 v95, v39, s42, v16
  v_cvt_pk_bf16_f32 v32, v80, v81
  v_cvt_pk_bf16_f32 v33, v82, v83
  v_cvt_pk_bf16_f32 v34, v84, v85
  v_cvt_pk_bf16_f32 v35, v86, v87
  ds_write_b128 v7, v[32:35] offset:0
  v_dot2_f32_bf16 v80, v40, s41, v16
  v_dot2_f32_bf16 v81, v40, s42, v16
  v_dot2_f32_bf16 v82, v41, s41, v16
  v_dot2_f32_bf16 v83, v41, s42, v16
  v_dot2_f32_bf16 v84, v42, s41, v16
  v_dot2_f32_bf16 v85, v42, s42, v16
  v_dot2_f32_bf16 v86, v43, s41, v16
  v_dot2_f32_bf16 v87, v43, s42, v16
  v_cvt_pk_bf16_f32 v36, v88, v89
  v_cvt_pk_bf16_f32 v37, v90, v91
  v_cvt_pk_bf16_f32 v38, v92, v93
  v_cvt_pk_bf16_f32 v39, v94, v95
  ds_write_b128 v7, v[36:39] offset:4224
  v_dot2_f32_bf16 v88, v44, s41, v16
  v_dot2_f32_bf16 v89, v44, s42, v16
  v_dot2_f32_bf16 v90, v45, s41, v16
  v_dot2_f32_bf16 v91, v45, s42, v16
  v_dot2_f32_bf16 v92, v46, s41, v16
  v_dot2_f32_bf16 v93, v46, s42, v16
  v_dot2_f32_bf16 v94, v47, s41, v16
  v_dot2_f32_bf16 v95, v47, s42, v16
  v_cvt_pk_bf16_f32 v40, v80, v81
  v_cvt_pk_bf16_f32 v41, v82, v83
  v_cvt_pk_bf16_f32 v42, v84, v85
  v_cvt_pk_bf16_f32 v43, v86, v87
  ds_write_b128 v7, v[40:43] offset:8448
  v_dot2_f32_bf16 v80, v48, s41, v16
  v_dot2_f32_bf16 v81, v48, s42, v16
  v_dot2_f32_bf16 v82, v49, s41, v16
  v_dot2_f32_bf16 v83, v49, s42, v16
  v_dot2_f32_bf16 v84, v50, s41, v16
  v_dot2_f32_bf16 v85, v50, s42, v16
  v_dot2_f32_bf16 v86, v51, s41, v16
  v_dot2_f32_bf16 v87, v51, s42, v16
  v_cvt_pk_bf16_f32 v44, v88, v89
  v_cvt_pk_bf16_f32 v45, v90, v91
  v_cvt_pk_bf16_f32 v46, v92, v93
  v_cvt_pk_bf16_f32 v47, v94, v95
  ds_write_b128 v7, v[44:47] offset:12672
  v_dot2_f32_bf16 v88, v52, s41, v16
  v_dot2_f32_bf16 v89, v52, s42, v16
  v_dot2_f32_bf16 v90, v53, s41, v16
  v_dot2_f32_bf16 v91, v53, s42, v16
  v_dot2_f32_bf16 v92, v54, s41, v16
  v_dot2_f32_bf16 v93, v54, s42, v16
  v_dot2_f32_bf16 v94, v55, s41, v16
  v_dot2_f32_bf16 v95, v55, s42, v16
  v_cvt_pk_bf16_f32 v48, v80, v81
  v_cvt_pk_bf16_f32 v49, v82, v83
  v_cvt_pk_bf16_f32 v50, v84, v85
  v_cvt_pk_bf16_f32 v51, v86, v87
  ds_write_b128 v7, v[48:51] offset:16896
  v_dot2_f32_bf16 v80, v56, s41, v16
  v_dot2_f32_bf16 v81, v56, s42, v16
  v_dot2_f32_bf16 v82, v57, s41, v16
  v_dot2_f32_bf16 v83, v57, s42, v16
  v_dot2_f32_bf16 v84, v58, s41, v16
  v_dot2_f32_bf16 v85, v58, s42, v16
  v_dot2_f32_bf16 v86, v59, s41, v16
  v_dot2_f32_bf16 v87, v59, s42, v16
  v_cvt_pk_bf16_f32 v52, v88, v89
  v_cvt_pk_bf16_f32 v53, v90, v91
  v_cvt_pk_bf16_f32 v54, v92, v93
  v_cvt_pk_bf16_f32 v55, v94, v95
  ds_write_b128 v7, v[52:55] offset:21120
  v_dot2_f32_bf16 v88, v60, s41, v16
  v_dot2_f32_bf16 v89, v60, s42, v16
  v_dot2_f32_bf16 v90, v61, s41, v16
  v_dot2_f32_bf16 v91, v61, s42, v16
  v_dot2_f32_bf16 v92, v62, s41, v16
  v_dot2_f32_bf16 v93, v62, s42, v16
  v_dot2_f32_bf16 v94, v63, s41, v16
  v_dot2_f32_bf16 v95, v63, s42, v16
  v_cvt_pk_bf16_f32 v56, v80, v81
  v_cvt_pk_bf16_f32 v57, v82, v83
  v_cvt_pk_bf16_f32 v58, v84, v85
  v_cvt_pk_bf16_f32 v59, v86, v87
  ds_write_b128 v7, v[56:59] offset:25344
  v_cvt_pk_bf16_f32 v60, v88, v89
  v_cvt_pk_bf16_f32 v61, v90, v91
  v_cvt_pk_bf16_f32 v62, v92, v93
  v_cvt_pk_bf16_f32 v63, v94, v95
  ds_write_b128 v7, v[60:63] offset:29568
  v_mov_b32 v16, 0
  v_mov_b32 v17, 0
  v_mov_b32 v18, 0
  v_mov_b32 v19, 0
  s_waitcnt vmcnt(8)
  v_dot2c_f32_bf16 v16, s40, v208
  v_dot2c_f32_bf16 v17, s40, v209
  v_dot2c_f32_bf16 v18, s40, v210
  v_dot2c_f32_bf16 v19, s40, v211
  s_waitcnt vmcnt(7)
  v_dot2c_f32_bf16 v16, s40, v212
  v_dot2c_f32_bf16 v17, s40, v213
  v_dot2c_f32_bf16 v18, s40, v214
  v_dot2c_f32_bf16 v19, s40, v215
  s_waitcnt vmcnt(6)
  v_dot2c_f32_bf16 v16, s40, v216
  v_dot2c_f32_bf16 v17, s40, v217
  v_dot2c_f32_bf16 v18, s40, v218
  v_dot2c_f32_bf16 v19, s40, v219
  s_waitcnt vmcnt(5)
  v_dot2c_f32_bf16 v16, s40, v220
  v_dot2c_f32_bf16 v17, s40, v221
  v_dot2c_f32_bf16 v18, s40, v222
  v_dot2c_f32_bf16 v19, s40, v223
  s_waitcnt vmcnt(4)
  v_dot2c_f32_bf16 v16, s40, v224
  v_dot2c_f32_bf16 v17, s40, v225
  v_dot2c_f32_bf16 v18, s40, v226
  v_dot2c_f32_bf16 v19, s40, v227
  s_waitcnt vmcnt(3)
  v_dot2c_f32_bf16 v16, s40, v228
  v_dot2c_f32_bf16 v17, s40, v229
  v_dot2c_f32_bf16 v18, s40, v230
  v_dot2c_f32_bf16 v19, s40, v231
  s_waitcnt vmcnt(2)
  v_dot2c_f32_bf16 v16, s40, v232
  v_dot2c_f32_bf16 v17, s40, v233
  v_dot2c_f32_bf16 v18, s40, v234
  v_dot2c_f32_bf16 v19, s40, v235
  s_waitcnt vmcnt(1)
  v_dot2c_f32_bf16 v16, s40, v236
  v_dot2c_f32_bf16 v17, s40, v237
  v_dot2c_f32_bf16 v18, s40, v238
  v_dot2c_f32_bf16 v19, s40, v239
  s_nop 0
  v_add_f32 v16, v16, v17
  s_nop 0
  v_add_f32 v18, v18, v19
  v_add_f32 v16, v16, v18
  s_nop 1
  v_add_f32 v16, v16, v16 quad_perm:[1,0,3,2] row_mask:0xf bank_mask:0xf
  s_nop 1
  v_add_f32 v16, v16, v16 quad_perm:[2,3,0,1] row_mask:0xf bank_mask:0xf
  s_nop 1
  v_add_f32 v16, v16, v16 row_half_mirror row_mask:0xf bank_mask:0xf
  v_mul_f32 v16, 0xbb000000, v16
  v_cvt_pk_bf16_f32 v16, v16, v16
  v_and_b32 v16, 0xffff0000, v16
  v_dot2_f32_bf16 v80, v208, s41, v16
  v_dot2_f32_bf16 v81, v208, s42, v16
  v_dot2_f32_bf16 v82, v209, s41, v16
  v_dot2_f32_bf16 v83, v209, s42, v16
  v_dot2_f32_bf16 v84, v210, s41, v16
  v_dot2_f32_bf16 v85, v210, s42, v16
  v_dot2_f32_bf16 v86, v211, s41, v16
  v_dot2_f32_bf16 v87, v211, s42, v16
  v_dot2_f32_bf16 v88, v212, s41, v16
  v_dot2_f32_bf16 v89, v212, s42, v16
  v_dot2_f32_bf16 v90, v213, s41, v16
  v_dot2_f32_bf16 v91, v213, s42, v16
  v_dot2_f32_bf16 v92, v214, s41, v16
  v_dot2_f32_bf16 v93, v214, s42, v16
  v_dot2_f32_bf16 v94, v215, s41, v16
  v_dot2_f32_bf16 v95, v215, s42, v16
  v_cvt_pk_bf16_f32 v208, v80, v81
  v_cvt_pk_bf16_f32 v209, v82, v83
  v_cvt_pk_bf16_f32 v210, v84, v85
  v_cvt_pk_bf16_f32 v211, v86, v87
  ds_write_b128 v7, v[208:211] offset:33792
  v_dot2_f32_bf16 v80, v216, s41, v16
  v_dot2_f32_bf16 v81, v216, s42, v16
  v_dot2_f32_bf16 v82, v217, s41, v16
  v_dot2_f32_bf16 v83, v217, s42, v16
  v_dot2_f32_bf16 v84, v218, s41, v16
  v_dot2_f32_bf16 v85, v218, s42, v16
  v_dot2_f32_bf16 v86, v219, s41, v16
  v_dot2_f32_bf16 v87, v219, s42, v16
  v_cvt_pk_bf16_f32 v212, v88, v89
  v_cvt_pk_bf16_f32 v213, v90, v91
  v_cvt_pk_bf16_f32 v214, v92, v93
  v_cvt_pk_bf16_f32 v215, v94, v95
  ds_write_b128 v7, v[212:215] offset:38016
  v_dot2_f32_bf16 v88, v220, s41, v16
  v_dot2_f32_bf16 v89, v220, s42, v16
  v_dot2_f32_bf16 v90, v221, s41, v16
  v_dot2_f32_bf16 v91, v221, s42, v16
  v_dot2_f32_bf16 v92, v222, s41, v16
  v_dot2_f32_bf16 v93, v222, s42, v16
  v_dot2_f32_bf16 v94, v223, s41, v16
  v_dot2_f32_bf16 v95, v223, s42, v16
  v_cvt_pk_bf16_f32 v216, v80, v81
  v_cvt_pk_bf16_f32 v217, v82, v83
  v_cvt_pk_bf16_f32 v218, v84, v85
  v_cvt_pk_bf16_f32 v219, v86, v87
  ds_write_b128 v7, v[216:219] offset:42240
  v_dot2_f32_bf16 v80, v224, s41, v16
  v_dot2_f32_bf16 v81, v224, s42, v16
  v_dot2_f32_bf16 v82, v225, s41, v16
  v_dot2_f32_bf16 v83, v225, s42, v16
  v_dot2_f32_bf16 v84, v226, s41, v16
  v_dot2_f32_bf16 v85, v226, s42, v16
  v_dot2_f32_bf16 v86, v227, s41, v16
  v_dot2_f32_bf16 v87, v227, s42, v16
  v_cvt_pk_bf16_f32 v220, v88, v89
  v_cvt_pk_bf16_f32 v221, v90, v91
  v_cvt_pk_bf16_f32 v222, v92, v93
  v_cvt_pk_bf16_f32 v223, v94, v95
  ds_write_b128 v7, v[220:223] offset:46464
  v_dot2_f32_bf16 v88, v228, s41, v16
  v_dot2_f32_bf16 v89, v228, s42, v16
  v_dot2_f32_bf16 v90, v229, s41, v16
  v_dot2_f32_bf16 v91, v229, s42, v16
  v_dot2_f32_bf16 v92, v230, s41, v16
  v_dot2_f32_bf16 v93, v230, s42, v16
  v_dot2_f32_bf16 v94, v231, s41, v16
  v_dot2_f32_bf16 v95, v231, s42, v16
  v_cvt_pk_bf16_f32 v224, v80, v81
  v_cvt_pk_bf16_f32 v225, v82, v83
  v_cvt_pk_bf16_f32 v226, v84, v85
  v_cvt_pk_bf16_f32 v227, v86, v87
  ds_write_b128 v7, v[224:227] offset:50688
  v_dot2_f32_bf16 v80, v232, s41, v16
  v_dot2_f32_bf16 v81, v232, s42, v16
  v_dot2_f32_bf16 v82, v233, s41, v16
  v_dot2_f32_bf16 v83, v233, s42, v16
  v_dot2_f32_bf16 v84, v234, s41, v16
  v_dot2_f32_bf16 v85, v234, s42, v16
  v_dot2_f32_bf16 v86, v235, s41, v16
  v_dot2_f32_bf16 v87, v235, s42, v16
  v_cvt_pk_bf16_f32 v228, v88, v89
  v_cvt_pk_bf16_f32 v229, v90, v91
  v_cvt_pk_bf16_f32 v230, v92, v93
  v_cvt_pk_bf16_f32 v231, v94, v95
  ds_write_b128 v7, v[228:231] offset:54912
  v_dot2_f32_bf16 v88, v236, s41, v16
  v_dot2_f32_bf16 v89, v236, s42, v16
  v_dot2_f32_bf16 v90, v237, s41, v16
  v_dot2_f32_bf16 v91, v237, s42, v16
  v_dot2_f32_bf16 v92, v238, s41, v16
  v_dot2_f32_bf16 v93, v238, s42, v16
  v_dot2_f32_bf16 v94, v239, s41, v16
  v_dot2_f32_bf16 v95, v239, s42, v16
  v_cvt_pk_bf16_f32 v232, v80, v81
  v_cvt_pk_bf16_f32 v233, v82, v83
  v_cvt_pk_bf16_f32 v234, v84, v85
  v_cvt_pk_bf16_f32 v235, v86, v87
  ds_write_b128 v7, v[232:235] offset:59136
  v_cvt_pk_bf16_f32 v236, v88, v89
  v_cvt_pk_bf16_f32 v237, v90, v91
  v_cvt_pk_bf16_f32 v238, v92, v93
  v_cvt_pk_bf16_f32 v239, v94, v95
  ds_write_b128 v7, v[236:239] offset:63360
  v_dot2c_f32_bf16 v100, v32, v32
  v_dot2c_f32_bf16 v102, v208, v208
  v_dot2c_f32_bf16 v101, v33, v33
  v_dot2c_f32_bf16 v103, v209, v209
  v_dot2c_f32_bf16 v100, v34, v34
  v_dot2c_f32_bf16 v102, v210, v210
  v_dot2c_f32_bf16 v101, v35, v35
  v_dot2c_f32_bf16 v103, v211, v211
  v_dot2c_f32_bf16 v100, v36, v36
  v_dot2c_f32_bf16 v102, v212, v212
  v_dot2c_f32_bf16 v101, v37, v37
  v_dot2c_f32_bf16 v103, v213, v213
  v_dot2c_f32_bf16 v100, v38, v38
  v_dot2c_f32_bf16 v102, v214, v214
  v_dot2c_f32_bf16 v101, v39, v39
  v_dot2c_f32_bf16 v103, v215, v215
  v_dot2c_f32_bf16 v100, v40, v40
  v_dot2c_f32_bf16 v102, v216, v216
  v_dot2c_f32_bf16 v101, v41, v41
  v_dot2c_f32_bf16 v103, v217, v217
  v_dot2c_f32_bf16 v100, v42, v42
  v_dot2c_f32_bf16 v102, v218, v218
  v_dot2c_f32_bf16 v101, v43, v43
  v_dot2c_f32_bf16 v103, v219, v219
  v_dot2c_f32_bf16 v100, v44, v44
  v_dot2c_f32_bf16 v102, v220, v220
  v_dot2c_f32_bf16 v101, v45, v45
  v_dot2c_f32_bf16 v103, v221, v221
  v_dot2c_f32_bf16 v100, v46, v46
  v_dot2c_f32_bf16 v102, v222, v222
  v_dot2c_f32_bf16 v101, v47, v47
  v_dot2c_f32_bf16 v103, v223, v223
  v_dot2c_f32_bf16 v100, v48, v48
  v_dot2c_f32_bf16 v102, v224, v224
  v_dot2c_f32_bf16 v101, v49, v49
  v_dot2c_f32_bf16 v103, v225, v225
  v_dot2c_f32_bf16 v100, v50, v50
  v_dot2c_f32_bf16 v102, v226, v226
  v_dot2c_f32_bf16 v101, v51, v51
  v_dot2c_f32_bf16 v103, v227, v227
  v_dot2c_f32_bf16 v100, v52, v52
  v_dot2c_f32_bf16 v102, v228, v228
  v_dot2c_f32_bf16 v101, v53, v53
  v_dot2c_f32_bf16 v103, v229, v229
  v_dot2c_f32_bf16 v100, v54, v54
  v_dot2c_f32_bf16 v102, v230, v230
  v_dot2c_f32_bf16 v101, v55, v55
  v_dot2c_f32_bf16 v103, v231, v231
  v_dot2c_f32_bf16 v100, v56, v56
  v_dot2c_f32_bf16 v102, v232, v232
  v_dot2c_f32_bf16 v101, v57, v57
  v_dot2c_f32_bf16 v103, v233, v233
  v_dot2c_f32_bf16 v100, v58, v58
  v_dot2c_f32_bf16 v102, v234, v234
  v_dot2c_f32_bf16 v101, v59, v59
  v_dot2c_f32_bf16 v103, v235, v235
  v_dot2c_f32_bf16 v100, v60, v60
  v_dot2c_f32_bf16 v102, v236, v236
  v_dot2c_f32_bf16 v101, v61, v61
  v_dot2c_f32_bf16 v103, v237, v237
  v_dot2c_f32_bf16 v100, v62, v62
  v_dot2c_f32_bf16 v102, v238, v238
  v_dot2c_f32_bf16 v101, v63, v63
  v_dot2c_f32_bf16 v103, v239, v239
  s_nop 1
  v_add_f32 v100, v100, v101
  v_add_f32 v102, v102, v103
  s_nop 0
  v_add_f32 v100, v100, v100 quad_perm:[1,0,3,2] row_mask:0xf bank_mask:0xf
  v_add_f32 v102, v102, v102 quad_perm:[1,0,3,2] row_mask:0xf bank_mask:0xf
  s_nop 0
  v_add_f32 v100, v100, v100 quad_perm:[2,3,0,1] row_mask:0xf bank_mask:0xf
  v_add_f32 v102, v102, v102 quad_perm:[2,3,0,1] row_mask:0xf bank_mask:0xf
  s_nop 0
  v_add_f32 v100, v100, v100 row_half_mirror row_mask:0xf bank_mask:0xf
  v_add_f32 v102, v102, v102 row_half_mirror row_mask:0xf bank_mask:0xf
  v_mul_f32 v100, 0x3b000000, v100
  v_mul_f32 v102, 0x3b000000, v102
  v_cvt_pk_bf16_f32 v100, v100, v100
  v_cvt_pk_bf16_f32 v102, v102, v102
  v_and_b32 v100, 0xffff0000, v100
  v_and_b32 v102, 0xffff0000, v102
  v_add_f32 v100, 0x3727c5ac, v100
  v_add_f32 v102, 0x3727c5ac, v102
  v_cvt_pk_bf16_f32 v100, v100, v100
  v_cvt_pk_bf16_f32 v102, v102, v102
  v_and_b32 v100, 0xffff0000, v100
  v_and_b32 v102, 0xffff0000, v102
  v_sqrt_f32 v100, v100
  v_sqrt_f32 v102, v102
  v_cvt_pk_bf16_f32 v100, v100, v100
  v_cvt_pk_bf16_f32 v102, v102, v102
  v_and_b32 v100, 0xffff0000, v100
  v_and_b32 v102, 0xffff0000, v102
  v_rcp_f32 v100, v100
  v_rcp_f32 v102, v102
  ds_write_b32 v8, v100
  ds_write_b32 v8, v102 offset:128
  s_and_b32 s24, s3, 1
  s_lshr_b32 s25, s3, 1
  s_load_dwordx2 s[40:41], s[0:1], 16
  s_mov_b32 s42, 0x80000
  s_mov_b32 s43, 0x00020000
  s_load_dwordx2 s[44:45], s[0:1], 48
  s_mov_b32 s46, 0x1c0000
  s_mov_b32 s47, 0x00020000
  v_and_b32 v11, 1, v1
  v_lshlrev_b32 v11, 1, v11
  v_bfe_u32 v10, v1, 1, 1
  v_or_b32 v10, v10, v11
  v_lshlrev_b32 v10, 3, v10
  v_bfe_u32 v11, v1, 3, 1
  v_lshl_or_b32 v10, v11, 6, v10
  v_bfe_u32 v11, v1, 2, 2
  v_lshl_or_b32 v10, v11, 7, v10
  v_lshrrev_b32 v11, 5, v1
  v_mad_u32_u24 v10, v11, s34, v10
  v_bfe_u32 v12, v1, 4, 1
  s_lshl_b32 s26, s25, 6
  v_xor_b32 v10, s26, v10
  v_lshl_or_b32 v13, v12, 5, v10
  v_add_u32 v22, 0x800, v13
  v_lshl_add_u32 v20, v12, 10, v13
  v_xor_b32 v21, 32, v20
  v_add_u32 v23, 0xc000, v20
  v_add_u32 v24, 0xc000, v21
  v_add_u32 v25, 0xc000, v22
  s_mul_i32 s26, s24, 33792
  s_add_u32 s26, s26, 86016
  v_and_b32 v27, 31, v1
  v_lshlrev_b32 v26, 4, v27
  s_movk_i32 s27, 528
  v_mad_u32_u24 v26, v11, s27, v26
  v_add_u32 v26, s26, v26
  s_lshl_b32 s26, s24, 7
  s_add_u32 s26, s26, 158208
  v_lshl_add_u32 v28, v27, 2, s26
  v_lshl_add_u32 v29, v11, 4, s26
  s_waitcnt lgkmcnt(0)
  s_barrier
  ds_read_b128 v[112:115], v26 offset:0
  ds_read_b128 v[116:119], v26 offset:1056
  ds_read_b128 v[120:123], v26 offset:2112
  ds_read_b64_tr_b16 v[128:129], v20 offset:0
  ds_read_b64_tr_b16 v[130:131], v20 offset:512
  ds_read_b64_tr_b16 v[132:133], v21 offset:0
  ds_read_b64_tr_b16 v[134:135], v21 offset:512
  ds_read_b64_tr_b16 v[136:137], v22 offset:0
  ds_read_b64_tr_b16 v[138:139], v22 offset:512
  ds_read_b64_tr_b16 v[140:141], v20 offset:6144
  ds_read_b64_tr_b16 v[142:143], v20 offset:6656
  ds_read_b64_tr_b16 v[144:145], v21 offset:6144
  ds_read_b64_tr_b16 v[146:147], v21 offset:6656
  ds_read_b64_tr_b16 v[148:149], v22 offset:6144
  ds_read_b64_tr_b16 v[150:151], v22 offset:6656
  ds_read_b64_tr_b16 v[152:153], v20 offset:12288
  ds_read_b64_tr_b16 v[154:155], v20 offset:12800
  ds_read_b64_tr_b16 v[156:157], v21 offset:12288
  ds_read_b64_tr_b16 v[158:159], v21 offset:12800
  s_waitcnt lgkmcnt(14)
  v_mfma_f32_32x32x16_bf16 v[64:79], v[128:131], v[112:115], 0
  ds_read_b64_tr_b16 v[160:161], v22 offset:12288
  ds_read_b64_tr_b16 v[162:163], v22 offset:12800
  s_waitcnt lgkmcnt(14)
  v_mfma_f32_32x32x16_bf16 v[80:95], v[132:135], v[112:115], 0
  ds_read_b128 v[124:127], v26 offset:3168
  ds_read_b64_tr_b16 v[164:165], v20 offset:18432
  ds_read_b64_tr_b16 v[166:167], v20 offset:18944
  s_waitcnt lgkmcnt(15)
  v_mfma_f32_32x32x16_bf16 v[96:111], v[112:115], v[136:139], 0
  ds_read_b64_tr_b16 v[168:169], v21 offset:18432
  ds_read_b64_tr_b16 v[170:171], v21 offset:18944
  s_waitcnt lgkmcnt(15)
  v_mfma_f32_32x32x16_bf16 v[64:79], v[140:143], v[116:119], v[64:79]
  ds_read_b64_tr_b16 v[172:173], v22 offset:18432
  ds_read_b64_tr_b16 v[174:175], v22 offset:18944
  s_waitcnt lgkmcnt(15)
  v_mfma_f32_32x32x16_bf16 v[80:95], v[144:147], v[116:119], v[80:95]
  ds_read_b128 v[112:115], v26 offset:4224
  s_waitcnt lgkmcnt(14)
  v_mfma_f32_32x32x16_bf16 v[96:111], v[116:119], v[148:151], v[96:111]
  s_barrier
  ds_read_b64_tr_b16 v[128:129], v20 offset:24576
  ds_read_b64_tr_b16 v[130:131], v20 offset:25088
  ds_read_b64_tr_b16 v[132:133], v21 offset:24576
  ds_read_b64_tr_b16 v[134:135], v21 offset:25088
  s_waitcnt lgkmcnt(15)
  v_mfma_f32_32x32x16_bf16 v[64:79], v[152:155], v[120:123], v[64:79]
  ds_read_b64_tr_b16 v[136:137], v22 offset:24576
  ds_read_b64_tr_b16 v[138:139], v22 offset:25088
  s_waitcnt lgkmcnt(15)
  v_mfma_f32_32x32x16_bf16 v[80:95], v[156:159], v[120:123], v[80:95]
  ds_read_b128 v[116:119], v26 offset:5280
  ds_read_b64_tr_b16 v[140:141], v20 offset:30720
  ds_read_b64_tr_b16 v[142:143], v20 offset:31232
  s_waitcnt lgkmcnt(15)
  v_mfma_f32_32x32x16_bf16 v[96:111], v[120:123], v[160:163], v[96:111]
  ds_read_b64_tr_b16 v[144:145], v21 offset:30720
  ds_read_b64_tr_b16 v[146:147], v21 offset:31232
  s_waitcnt lgkmcnt(15)
  v_mfma_f32_32x32x16_bf16 v[64:79], v[164:167], v[124:127], v[64:79]
  ds_read_b64_tr_b16 v[148:149], v22 offset:30720
  ds_read_b64_tr_b16 v[150:151], v22 offset:31232
  s_waitcnt lgkmcnt(15)
  v_mfma_f32_32x32x16_bf16 v[80:95], v[168:171], v[124:127], v[80:95]
  ds_read_b128 v[120:123], v26 offset:6336
  s_waitcnt lgkmcnt(15)
  v_mfma_f32_32x32x16_bf16 v[96:111], v[124:127], v[172:175], v[96:111]
  s_barrier
  ds_read_b64_tr_b16 v[152:153], v20 offset:36864
  ds_read_b64_tr_b16 v[154:155], v20 offset:37376
  ds_read_b64_tr_b16 v[156:157], v21 offset:36864
  ds_read_b64_tr_b16 v[158:159], v21 offset:37376
  s_waitcnt lgkmcnt(15)
  v_mfma_f32_32x32x16_bf16 v[64:79], v[128:131], v[112:115], v[64:79]
  ds_read_b64_tr_b16 v[160:161], v22 offset:36864
  ds_read_b64_tr_b16 v[162:163], v22 offset:37376
  s_waitcnt lgkmcnt(15)
  v_mfma_f32_32x32x16_bf16 v[80:95], v[132:135], v[112:115], v[80:95]
  ds_read_b128 v[124:127], v26 offset:7392
  ds_read_b64_tr_b16 v[164:165], v20 offset:43008
  ds_read_b64_tr_b16 v[166:167], v20 offset:43520
  s_waitcnt lgkmcnt(15)
  v_mfma_f32_32x32x16_bf16 v[96:111], v[112:115], v[136:139], v[96:111]
  ds_read_b64_tr_b16 v[168:169], v21 offset:43008
  ds_read_b64_tr_b16 v[170:171], v21 offset:43520
  s_waitcnt lgkmcnt(15)
  v_mfma_f32_32x32x16_bf16 v[64:79], v[140:143], v[116:119], v[64:79]
  ds_read_b64_tr_b16 v[172:173], v22 offset:43008
  ds_read_b64_tr_b16 v[174:175], v22 offset:43520
  s_waitcnt lgkmcnt(15)
  v_mfma_f32_32x32x16_bf16 v[80:95], v[144:147], v[116:119], v[80:95]
  ds_read_b128 v[112:115], v26 offset:8448
  s_waitcnt lgkmcnt(15)
  v_mfma_f32_32x32x16_bf16 v[96:111], v[116:119], v[148:151], v[96:111]
  s_barrier
  ds_read_b64_tr_b16 v[128:129], v23 offset:0
  ds_read_b64_tr_b16 v[130:131], v23 offset:512
  ds_read_b64_tr_b16 v[132:133], v24 offset:0
  ds_read_b64_tr_b16 v[134:135], v24 offset:512
  s_waitcnt lgkmcnt(15)
  v_mfma_f32_32x32x16_bf16 v[64:79], v[152:155], v[120:123], v[64:79]
  ds_read_b64_tr_b16 v[136:137], v25 offset:0
  ds_read_b64_tr_b16 v[138:139], v25 offset:512
  s_waitcnt lgkmcnt(15)
  v_mfma_f32_32x32x16_bf16 v[80:95], v[156:159], v[120:123], v[80:95]
  ds_read_b128 v[116:119], v26 offset:9504
  ds_read_b64_tr_b16 v[140:141], v23 offset:6144
  ds_read_b64_tr_b16 v[142:143], v23 offset:6656
  s_lshl_b32 s26, s7, 2
  s_add_u32 s26, s26, s3
  s_lshl_b32 s27, s26, 15
  s_lshl_b32 s28, s6, 7
  s_add_u32 s27, s27, s28
  v_lshrrev_b32 v30, 1, v1
  v_lshlrev_b32 v30, 10, v30
  v_and_b32 v9, 1, v1
  v_lshl_or_b32 v30, v9, 6, v30
  buffer_load_dword v192, v30, s[40:43], s27 offen
  s_waitcnt lgkmcnt(15)
  v_mfma_f32_32x32x16_bf16 v[96:111], v[120:123], v[160:163], v[96:111]
  ds_read_b64_tr_b16 v[144:145], v24 offset:6144
  ds_read_b64_tr_b16 v[146:147], v24 offset:6656
  s_waitcnt lgkmcnt(15)
  v_mfma_f32_32x32x16_bf16 v[64:79], v[164:167], v[124:127], v[64:79]
  ds_read_b64_tr_b16 v[148:149], v25 offset:6144
  ds_read_b64_tr_b16 v[150:151], v25 offset:6656
  s_waitcnt lgkmcnt(15)
  v_mfma_f32_32x32x16_bf16 v[80:95], v[168:171], v[124:127], v[80:95]
  ds_read_b128 v[120:123], v26 offset:10560
  s_waitcnt lgkmcnt(15)
  v_mfma_f32_32x32x16_bf16 v[96:111], v[124:127], v[172:175], v[96:111]
  s_barrier
  ds_read_b64_tr_b16 v[152:153], v23 offset:12288
  ds_read_b64_tr_b16 v[154:155], v23 offset:12800
  ds_read_b64_tr_b16 v[156:157], v24 offset:12288
  ds_read_b64_tr_b16 v[158:159], v24 offset:12800
  s_waitcnt lgkmcnt(15)
  v_mfma_f32_32x32x16_bf16 v[64:79], v[128:131], v[112:115], v[64:79]
  ds_read_b64_tr_b16 v[160:161], v25 offset:12288
  ds_read_b64_tr_b16 v[162:163], v25 offset:12800
  s_waitcnt lgkmcnt(15)
  v_mfma_f32_32x32x16_bf16 v[80:95], v[132:135], v[112:115], v[80:95]
  ds_read_b128 v[124:127], v26 offset:11616
  ds_read_b64_tr_b16 v[164:165], v23 offset:18432
  ds_read_b64_tr_b16 v[166:167], v23 offset:18944
  s_waitcnt lgkmcnt(15)
  v_mfma_f32_32x32x16_bf16 v[96:111], v[112:115], v[136:139], v[96:111]
  ds_read_b64_tr_b16 v[168:169], v24 offset:18432
  ds_read_b64_tr_b16 v[170:171], v24 offset:18944
  s_waitcnt lgkmcnt(15)
  v_mfma_f32_32x32x16_bf16 v[64:79], v[140:143], v[116:119], v[64:79]
  ds_read_b64_tr_b16 v[172:173], v25 offset:18432
  ds_read_b64_tr_b16 v[174:175], v25 offset:18944
  s_waitcnt lgkmcnt(15)
  v_mfma_f32_32x32x16_bf16 v[80:95], v[144:147], v[116:119], v[80:95]
  ds_read_b128 v[112:115], v26 offset:12672
  s_waitcnt lgkmcnt(15)
  v_mfma_f32_32x32x16_bf16 v[96:111], v[116:119], v[148:151], v[96:111]
  s_barrier
  ds_read_b64_tr_b16 v[128:129], v23 offset:24576
  ds_read_b64_tr_b16 v[130:131], v23 offset:25088
  ds_read_b64_tr_b16 v[132:133], v24 offset:24576
  ds_read_b64_tr_b16 v[134:135], v24 offset:25088
  s_waitcnt lgkmcnt(15)
  v_mfma_f32_32x32x16_bf16 v[64:79], v[152:155], v[120:123], v[64:79]
  s_lshl_b32 s30, s6, 2
  s_lshl_b32 s31, s25, 1
  s_add_u32 s30, s30, s31
  ds_read_b64_tr_b16 v[136:137], v25 offset:24576
  ds_read_b64_tr_b16 v[138:139], v25 offset:25088
  s_waitcnt lgkmcnt(15)
  v_mfma_f32_32x32x16_bf16 v[80:95], v[156:159], v[120:123], v[80:95]
  s_lshl_b32 s30, s30, 16
  s_lshl_b32 s31, s32, 1
  s_add_u32 s31, s31, s24
  ds_read_b128 v[116:119], v26 offset:13728
  ds_read_b64_tr_b16 v[140:141], v23 offset:30720
  ds_read_b64_tr_b16 v[142:143], v23 offset:31232
  s_waitcnt lgkmcnt(15)
  v_mfma_f32_32x32x16_bf16 v[96:111], v[120:123], v[160:163], v[96:111]
  s_lshl_b32 s31, s31, 10
  s_add_u32 s30, s30, s31
  s_add_u32 s31, s30, 0x200000
  ds_read_b64_tr_b16 v[144:145], v24 offset:30720
  ds_read_b64_tr_b16 v[146:147], v24 offset:31232
  s_waitcnt lgkmcnt(15)
  v_mfma_f32_32x32x16_bf16 v[64:79], v[164:167], v[124:127], v[64:79]
  s_add_u32 s36, s30, 0x10000
  s_add_u32 s37, s31, 0x10000
  s_add_u32 s38, s30, 0x400000
  ds_read_b64_tr_b16 v[148:149], v25 offset:30720
  ds_read_b64_tr_b16 v[150:151], v25 offset:31232
  s_waitcnt lgkmcnt(15)
  v_mfma_f32_32x32x16_bf16 v[80:95], v[168:171], v[124:127], v[80:95]
  s_lshl_b32 s39, s6, 1
  s_add_u32 s39, s39, s25
  s_lshl_b32 s39, s39, 3
  ds_read_b128 v[120:123], v26 offset:14784
  s_waitcnt lgkmcnt(15)
  v_mfma_f32_32x32x16_bf16 v[96:111], v[124:127], v[172:175], v[96:111]
  s_add_u32 s39, s39, s4
  s_lshl_b32 s39, s39, 2
  s_add_u32 s39, s39, s7
  s_barrier
  ds_read_b64_tr_b16 v[152:153], v20 offset:0
  ds_read_b64_tr_b16 v[154:155], v20 offset:512
  ds_read_b64_tr_b16 v[156:157], v21 offset:0
  ds_read_b64_tr_b16 v[158:159], v21 offset:512
  s_waitcnt lgkmcnt(15)
  v_mfma_f32_32x32x16_bf16 v[64:79], v[128:131], v[112:115], v[64:79]
  s_lshl_b32 s39, s39, 1
  s_add_u32 s39, s39, s24
  s_lshl_b32 s39, s39, 7
  ds_read_b64_tr_b16 v[160:161], v22 offset:0
  ds_read_b64_tr_b16 v[162:163], v22 offset:512
  s_waitcnt lgkmcnt(15)
  v_mfma_f32_32x32x16_bf16 v[80:95], v[132:135], v[112:115], v[80:95]
  s_add_u32 s39, s39, 0x2000000
  v_lshlrev_b32 v2, 4, v1
  v_and_b32 v15, 15, v1
  ds_read_b128 v[124:127], v26 offset:15840
  ds_read_b64_tr_b16 v[164:165], v20 offset:6144
  ds_read_b64_tr_b16 v[166:167], v20 offset:6656
  s_waitcnt lgkmcnt(15)
  v_mfma_f32_32x32x16_bf16 v[96:111], v[112:115], v[136:139], v[96:111]
  v_lshlrev_b32 v15, 4, v15
  v_lshl_add_u32 v15, v11, 8, v15
  v_bfe_u32 v14, v1, 4, 1
  ds_read_b64_tr_b16 v[168:169], v21 offset:6144
  ds_read_b64_tr_b16 v[170:171], v21 offset:6656
  s_waitcnt lgkmcnt(15)
  v_mfma_f32_32x32x16_bf16 v[64:79], v[140:143], v[116:119], v[64:79]
  v_lshl_add_u32 v14, v14, 16, v15
  ds_read_b64_tr_b16 v[172:173], v22 offset:6144
  ds_read_b64_tr_b16 v[174:175], v22 offset:6656
  buffer_load_dwordx2 v[196:197], off, s[20:23], 0 sc1
  s_waitcnt lgkmcnt(15)
  v_mfma_f32_32x32x16_bf16 v[80:95], v[144:147], v[116:119], v[80:95]
  ds_read_b128 v[112:115], v26 offset:16896
  s_waitcnt lgkmcnt(15)
  v_mfma_f32_32x32x16_bf16 v[96:111], v[116:119], v[148:151], v[96:111]
  s_barrier
  ds_read_b64_tr_b16 v[128:129], v20 offset:12288
  ds_read_b64_tr_b16 v[130:131], v20 offset:12800
  ds_read_b64_tr_b16 v[132:133], v21 offset:12288
  ds_read_b64_tr_b16 v[134:135], v21 offset:12800
  s_waitcnt lgkmcnt(15)
  v_mfma_f32_32x32x16_bf16 v[64:79], v[152:155], v[120:123], v[64:79]
  ds_read_b64_tr_b16 v[136:137], v22 offset:12288
  ds_read_b64_tr_b16 v[138:139], v22 offset:12800
  s_waitcnt lgkmcnt(15)
  v_mfma_f32_32x32x16_bf16 v[80:95], v[156:159], v[120:123], v[80:95]
  ds_read_b128 v[116:119], v26 offset:17952
  ds_read_b64_tr_b16 v[140:141], v20 offset:18432
  ds_read_b64_tr_b16 v[142:143], v20 offset:18944
  s_waitcnt lgkmcnt(15)
  v_mfma_f32_32x32x16_bf16 v[96:111], v[120:123], v[160:163], v[96:111]
  ds_read_b64_tr_b16 v[144:145], v21 offset:18432
  ds_read_b64_tr_b16 v[146:147], v21 offset:18944
  s_waitcnt lgkmcnt(15)
  v_mfma_f32_32x32x16_bf16 v[64:79], v[164:167], v[124:127], v[64:79]
  ds_read_b64_tr_b16 v[148:149], v22 offset:18432
  ds_read_b64_tr_b16 v[150:151], v22 offset:18944
  s_waitcnt lgkmcnt(15)
  v_mfma_f32_32x32x16_bf16 v[80:95], v[168:171], v[124:127], v[80:95]
  ds_read_b128 v[120:123], v26 offset:19008
  s_waitcnt lgkmcnt(15)
  v_mfma_f32_32x32x16_bf16 v[96:111], v[124:127], v[172:175], v[96:111]
  s_barrier
  ds_read_b64_tr_b16 v[152:153], v20 offset:24576
  ds_read_b64_tr_b16 v[154:155], v20 offset:25088
  ds_read_b64_tr_b16 v[156:157], v21 offset:24576
  ds_read_b64_tr_b16 v[158:159], v21 offset:25088
  s_waitcnt lgkmcnt(15)
  v_mfma_f32_32x32x16_bf16 v[64:79], v[128:131], v[112:115], v[64:79]
  ds_read_b64_tr_b16 v[160:161], v22 offset:24576
  ds_read_b64_tr_b16 v[162:163], v22 offset:25088
  s_waitcnt lgkmcnt(15)
  v_mfma_f32_32x32x16_bf16 v[80:95], v[132:135], v[112:115], v[80:95]
  ds_read_b128 v[124:127], v26 offset:20064
  ds_read_b64_tr_b16 v[164:165], v20 offset:30720
  ds_read_b64_tr_b16 v[166:167], v20 offset:31232
  s_waitcnt lgkmcnt(15)
  v_mfma_f32_32x32x16_bf16 v[96:111], v[112:115], v[136:139], v[96:111]
  ds_read_b64_tr_b16 v[168:169], v21 offset:30720
  ds_read_b64_tr_b16 v[170:171], v21 offset:31232
  s_waitcnt lgkmcnt(15)
  v_mfma_f32_32x32x16_bf16 v[64:79], v[140:143], v[116:119], v[64:79]
  ds_read_b64_tr_b16 v[172:173], v22 offset:30720
  ds_read_b64_tr_b16 v[174:175], v22 offset:31232
  s_waitcnt lgkmcnt(15)
  v_mfma_f32_32x32x16_bf16 v[80:95], v[144:147], v[116:119], v[80:95]
  ds_read_b128 v[112:115], v26 offset:21120
  s_waitcnt lgkmcnt(15)
  v_mfma_f32_32x32x16_bf16 v[96:111], v[116:119], v[148:151], v[96:111]
  s_barrier
  ds_read_b64_tr_b16 v[128:129], v20 offset:36864
  ds_read_b64_tr_b16 v[130:131], v20 offset:37376
  ds_read_b64_tr_b16 v[132:133], v21 offset:36864
  ds_read_b64_tr_b16 v[134:135], v21 offset:37376
  s_waitcnt lgkmcnt(15)
  v_mfma_f32_32x32x16_bf16 v[64:79], v[152:155], v[120:123], v[64:79]
  ds_read_b64_tr_b16 v[136:137], v22 offset:36864
  ds_read_b64_tr_b16 v[138:139], v22 offset:37376
  s_waitcnt lgkmcnt(15)
  v_mfma_f32_32x32x16_bf16 v[80:95], v[156:159], v[120:123], v[80:95]
  ds_read_b128 v[116:119], v26 offset:22176
  ds_read_b64_tr_b16 v[140:141], v20 offset:43008
  ds_read_b64_tr_b16 v[142:143], v20 offset:43520
  s_waitcnt lgkmcnt(15)
  v_mfma_f32_32x32x16_bf16 v[96:111], v[120:123], v[160:163], v[96:111]
  ds_read_b64_tr_b16 v[144:145], v21 offset:43008
  ds_read_b64_tr_b16 v[146:147], v21 offset:43520
  s_waitcnt lgkmcnt(15)
  v_mfma_f32_32x32x16_bf16 v[64:79], v[164:167], v[124:127], v[64:79]
  ds_read_b64_tr_b16 v[148:149], v22 offset:43008
  ds_read_b64_tr_b16 v[150:151], v22 offset:43520
  s_waitcnt lgkmcnt(15)
  v_mfma_f32_32x32x16_bf16 v[80:95], v[168:171], v[124:127], v[80:95]
  ds_read_b128 v[120:123], v26 offset:23232
  s_waitcnt lgkmcnt(15)
  v_mfma_f32_32x32x16_bf16 v[96:111], v[124:127], v[172:175], v[96:111]
  s_barrier
  ds_read_b64_tr_b16 v[152:153], v23 offset:0
  ds_read_b64_tr_b16 v[154:155], v23 offset:512
  ds_read_b64_tr_b16 v[156:157], v24 offset:0
  ds_read_b64_tr_b16 v[158:159], v24 offset:512
  s_waitcnt lgkmcnt(15)
  v_mfma_f32_32x32x16_bf16 v[64:79], v[128:131], v[112:115], v[64:79]
  ds_read_b64_tr_b16 v[160:161], v25 offset:0
  ds_read_b64_tr_b16 v[162:163], v25 offset:512
  s_waitcnt lgkmcnt(15)
  v_mfma_f32_32x32x16_bf16 v[80:95], v[132:135], v[112:115], v[80:95]
  ds_read_b128 v[124:127], v26 offset:24288
  ds_read_b64_tr_b16 v[164:165], v23 offset:6144
  ds_read_b64_tr_b16 v[166:167], v23 offset:6656
  s_waitcnt lgkmcnt(15)
  v_mfma_f32_32x32x16_bf16 v[96:111], v[112:115], v[136:139], v[96:111]
  ds_read_b64_tr_b16 v[168:169], v24 offset:6144
  ds_read_b64_tr_b16 v[170:171], v24 offset:6656
  s_waitcnt lgkmcnt(15)
  v_mfma_f32_32x32x16_bf16 v[64:79], v[140:143], v[116:119], v[64:79]
  ds_read_b64_tr_b16 v[172:173], v25 offset:6144
  ds_read_b64_tr_b16 v[174:175], v25 offset:6656
  s_waitcnt lgkmcnt(15)
  v_mfma_f32_32x32x16_bf16 v[80:95], v[144:147], v[116:119], v[80:95]
  ds_read_b128 v[112:115], v26 offset:25344
  s_waitcnt lgkmcnt(15)
  v_mfma_f32_32x32x16_bf16 v[96:111], v[116:119], v[148:151], v[96:111]
  s_barrier
  ds_read_b64_tr_b16 v[128:129], v23 offset:12288
  ds_read_b64_tr_b16 v[130:131], v23 offset:12800
  ds_read_b64_tr_b16 v[132:133], v24 offset:12288
  ds_read_b64_tr_b16 v[134:135], v24 offset:12800
  s_waitcnt lgkmcnt(15)
  v_mfma_f32_32x32x16_bf16 v[64:79], v[152:155], v[120:123], v[64:79]
  ds_read_b64_tr_b16 v[136:137], v25 offset:12288
  ds_read_b64_tr_b16 v[138:139], v25 offset:12800
  s_waitcnt lgkmcnt(15)
  v_mfma_f32_32x32x16_bf16 v[80:95], v[156:159], v[120:123], v[80:95]
  ds_read_b128 v[116:119], v26 offset:26400
  ds_read_b64_tr_b16 v[140:141], v23 offset:18432
  ds_read_b64_tr_b16 v[142:143], v23 offset:18944
  s_waitcnt lgkmcnt(15)
  v_mfma_f32_32x32x16_bf16 v[96:111], v[120:123], v[160:163], v[96:111]
  ds_read_b64_tr_b16 v[144:145], v24 offset:18432
  ds_read_b64_tr_b16 v[146:147], v24 offset:18944
  s_waitcnt lgkmcnt(15)
  v_mfma_f32_32x32x16_bf16 v[64:79], v[164:167], v[124:127], v[64:79]
  ds_read_b64_tr_b16 v[148:149], v25 offset:18432
  ds_read_b64_tr_b16 v[150:151], v25 offset:18944
  s_waitcnt lgkmcnt(15)
  v_mfma_f32_32x32x16_bf16 v[80:95], v[168:171], v[124:127], v[80:95]
  ds_read_b128 v[120:123], v26 offset:27456
  s_waitcnt lgkmcnt(15)
  v_mfma_f32_32x32x16_bf16 v[96:111], v[124:127], v[172:175], v[96:111]
  s_barrier
  ds_read_b64_tr_b16 v[152:153], v23 offset:24576
  ds_read_b64_tr_b16 v[154:155], v23 offset:25088
  ds_read_b64_tr_b16 v[156:157], v24 offset:24576
  ds_read_b64_tr_b16 v[158:159], v24 offset:25088
  ds_read_b32 v12, v28
  ds_read_b128 v[176:179], v29 offset:0
  ds_read_b128 v[180:183], v29 offset:32
  ds_read_b128 v[184:187], v29 offset:64
  ds_read_b128 v[188:191], v29 offset:96
  s_waitcnt lgkmcnt(15)
  v_mfma_f32_32x32x16_bf16 v[64:79], v[128:131], v[112:115], v[64:79]
  ds_read_b64_tr_b16 v[160:161], v25 offset:24576
  ds_read_b64_tr_b16 v[162:163], v25 offset:25088
  v_mfma_f32_32x32x16_bf16 v[80:95], v[132:135], v[112:115], v[80:95]
  ds_read_b128 v[124:127], v26 offset:28512
  ds_read_b64_tr_b16 v[164:165], v23 offset:30720
  ds_read_b64_tr_b16 v[166:167], v23 offset:31232
  v_mfma_f32_32x32x16_bf16 v[96:111], v[112:115], v[136:139], v[96:111]
  ds_read_b64_tr_b16 v[168:169], v24 offset:30720
  ds_read_b64_tr_b16 v[170:171], v24 offset:31232
  s_waitcnt lgkmcnt(15)
  v_mfma_f32_32x32x16_bf16 v[64:79], v[140:143], v[116:119], v[64:79]
  ds_read_b64_tr_b16 v[172:173], v25 offset:30720
  ds_read_b64_tr_b16 v[174:175], v25 offset:31232
  v_mfma_f32_32x32x16_bf16 v[80:95], v[144:147], v[116:119], v[80:95]
  ds_read_b128 v[112:115], v26 offset:29568
  v_mfma_f32_32x32x16_bf16 v[96:111], v[116:119], v[148:151], v[96:111]
  s_barrier
  ds_read_b64_tr_b16 v[128:129], v20 offset:0
  ds_read_b64_tr_b16 v[130:131], v20 offset:512
  ds_read_b64_tr_b16 v[132:133], v21 offset:0
  ds_read_b64_tr_b16 v[134:135], v21 offset:512
  s_waitcnt lgkmcnt(15)
  v_mfma_f32_32x32x16_bf16 v[64:79], v[152:155], v[120:123], v[64:79]
  ds_read_b64_tr_b16 v[136:137], v22 offset:0
  ds_read_b64_tr_b16 v[138:139], v22 offset:512
  v_mfma_f32_32x32x16_bf16 v[80:95], v[156:159], v[120:123], v[80:95]
  ds_read_b128 v[116:119], v26 offset:30624
  ds_read_b64_tr_b16 v[140:141], v20 offset:6144
  ds_read_b64_tr_b16 v[142:143], v20 offset:6656
  s_waitcnt lgkmcnt(15)
  v_mfma_f32_32x32x16_bf16 v[96:111], v[120:123], v[160:163], v[96:111]
  ds_read_b64_tr_b16 v[144:145], v21 offset:6144
  ds_read_b64_tr_b16 v[146:147], v21 offset:6656
  s_waitcnt lgkmcnt(15)
  v_mfma_f32_32x32x16_bf16 v[64:79], v[164:167], v[124:127], v[64:79]
  ds_read_b64_tr_b16 v[148:149], v22 offset:6144
  ds_read_b64_tr_b16 v[150:151], v22 offset:6656
  s_waitcnt lgkmcnt(15)
  v_mfma_f32_32x32x16_bf16 v[80:95], v[168:171], v[124:127], v[80:95]
  ds_read_b128 v[120:123], v26 offset:31680
  s_waitcnt lgkmcnt(15)
  v_mfma_f32_32x32x16_bf16 v[96:111], v[124:127], v[172:175], v[96:111]
  s_barrier
  ds_read_b64_tr_b16 v[152:153], v20 offset:12288
  ds_read_b64_tr_b16 v[154:155], v20 offset:12800
  ds_read_b64_tr_b16 v[156:157], v21 offset:12288
  ds_read_b64_tr_b16 v[158:159], v21 offset:12800
  s_waitcnt lgkmcnt(15)
  v_mfma_f32_32x32x16_bf16 v[64:79], v[128:131], v[112:115], v[64:79]
  ds_read_b64_tr_b16 v[160:161], v22 offset:12288
  ds_read_b64_tr_b16 v[162:163], v22 offset:12800
  s_waitcnt lgkmcnt(15)
  v_mfma_f32_32x32x16_bf16 v[80:95], v[132:135], v[112:115], v[80:95]
  ds_read_b128 v[124:127], v26 offset:32736
  ds_read_b64_tr_b16 v[164:165], v20 offset:18432
  ds_read_b64_tr_b16 v[166:167], v20 offset:18944
  s_waitcnt lgkmcnt(15)
  v_mfma_f32_32x32x16_bf16 v[96:111], v[112:115], v[136:139], v[96:111]
  ds_read_b64_tr_b16 v[168:169], v21 offset:18432
  ds_read_b64_tr_b16 v[170:171], v21 offset:18944
  s_waitcnt lgkmcnt(15)
  v_mfma_f32_32x32x16_bf16 v[64:79], v[140:143], v[116:119], v[64:79]
  ds_read_b64_tr_b16 v[172:173], v22 offset:18432
  ds_read_b64_tr_b16 v[174:175], v22 offset:18944
  s_waitcnt lgkmcnt(15)
  v_mfma_f32_32x32x16_bf16 v[80:95], v[144:147], v[116:119], v[80:95]
  s_waitcnt lgkmcnt(14)
  v_mfma_f32_32x32x16_bf16 v[96:111], v[116:119], v[148:151], v[96:111]
  s_waitcnt lgkmcnt(11)
  v_mfma_f32_32x32x16_bf16 v[64:79], v[152:155], v[120:123], v[64:79]
  s_waitcnt lgkmcnt(9)
  v_mfma_f32_32x32x16_bf16 v[80:95], v[156:159], v[120:123], v[80:95]
  s_waitcnt lgkmcnt(7)
  v_mfma_f32_32x32x16_bf16 v[96:111], v[120:123], v[160:163], v[96:111]
  s_waitcnt lgkmcnt(4)
  v_mfma_f32_32x32x16_bf16 v[64:79], v[164:167], v[124:127], v[64:79]
  s_waitcnt lgkmcnt(2)
  v_mfma_f32_32x32x16_bf16 v[80:95], v[168:171], v[124:127], v[80:95]
  s_waitcnt lgkmcnt(0)
  v_mfma_f32_32x32x16_bf16 v[96:111], v[124:127], v[172:175], v[96:111]
  v_mul_f32 v13, 0x3eb8aa3b, v12
EL_kz_ker_3:
  s_waitcnt vmcnt(0)
  v_readfirstlane_b32 s56, v196
  v_readfirstlane_b32 s57, v197
  s_bitcmp1_b32 s57, 31
  s_cbranch_scc1 ED_kz_ker_4
  buffer_load_dwordx2 v[196:197], off, s[20:23], 0 sc1
  s_sub_u32 s60, s60, 1
  s_cbranch_scc0 EL_kz_ker_3
  s_mov_b32 s60, 0
ED_kz_ker_4:
  s_getreg_b32 s58, hwreg(HW_REG_XCC_ID)
  s_and_b32 s58, s58, 15
  s_add_u32 s58, s58, s56
  s_mov_b32 s59, s57
  s_waitcnt lgkmcnt(0)
  s_barrier
  v_mul_f32 v72, v72, v12
  v_mul_f32 v73, v73, v12
  v_mul_f32 v74, v74, v12
  v_mul_f32 v75, v75, v12
  v_mul_f32 v76, v76, v12
  v_mul_f32 v77, v77, v12
  v_mul_f32 v78, v78, v12
  v_mul_f32 v79, v79, v12
  v_cvt_pk_bf16_f32 v132, v72, v73
  v_cvt_pk_bf16_f32 v133, v74, v75
  v_cvt_pk_bf16_f32 v134, v76, v77
  v_cvt_pk_bf16_f32 v135, v78, v79
  buffer_store_dwordx4 v[132:135], v2, s[8:11], s31 offen sc1
  v_mul_f32 v88, v88, v12
  v_mul_f32 v89, v89, v12
  v_mul_f32 v90, v90, v12
  v_mul_f32 v91, v91, v12
  v_mul_f32 v92, v92, v12
  v_mul_f32 v93, v93, v12
  v_mul_f32 v94, v94, v12
  v_mul_f32 v95, v95, v12
  v_cvt_pk_bf16_f32 v140, v88, v89
  v_cvt_pk_bf16_f32 v141, v90, v91
  v_cvt_pk_bf16_f32 v142, v92, v93
  v_cvt_pk_bf16_f32 v143, v94, v95
  buffer_store_dwordx4 v[140:143], v2, s[8:11], s37 offen sc1
  v_mul_f32 v96, v96, v176
  v_mul_f32 v97, v97, v177
  v_mul_f32 v98, v98, v178
  v_mul_f32 v99, v99, v179
  v_mul_f32 v100, v100, v180
  v_mul_f32 v101, v101, v181
  v_mul_f32 v102, v102, v182
  v_mul_f32 v103, v103, v183
  v_cvt_pk_bf16_f32 v144, v96, v97
  v_cvt_pk_bf16_f32 v145, v98, v99
  v_cvt_pk_bf16_f32 v146, v100, v101
  v_cvt_pk_bf16_f32 v147, v102, v103
  buffer_store_dwordx4 v[144:147], v14, s[8:11], s38 offen offset:0 sc1
  v_mul_f32 v104, v104, v184
  v_mul_f32 v105, v105, v185
  v_mul_f32 v106, v106, v186
  v_mul_f32 v107, v107, v187
  v_mul_f32 v108, v108, v188
  v_mul_f32 v109, v109, v189
  v_mul_f32 v110, v110, v190
  v_mul_f32 v111, v111, v191
  v_cvt_pk_bf16_f32 v148, v104, v105
  v_cvt_pk_bf16_f32 v149, v106, v107
  v_cvt_pk_bf16_f32 v150, v108, v109
  v_cvt_pk_bf16_f32 v151, v110, v111
  buffer_store_dwordx4 v[148:151], v14, s[8:11], s38 offen offset:512 sc1
  v_mul_f32 v64, v64, v13
  v_mul_f32 v65, v65, v13
  v_mul_f32 v66, v66, v13
  v_mul_f32 v67, v67, v13
  v_mul_f32 v68, v68, v13
  v_mul_f32 v69, v69, v13
  v_mul_f32 v70, v70, v13
  v_mul_f32 v71, v71, v13
  v_cvt_pk_bf16_f32 v128, v64, v65
  v_cvt_pk_bf16_f32 v129, v66, v67
  v_cvt_pk_bf16_f32 v130, v68, v69
  v_cvt_pk_bf16_f32 v131, v70, v71
  buffer_store_dwordx4 v[128:131], v2, s[8:11], s30 offen sc1
  v_mul_f32 v80, v80, v13
  v_mul_f32 v81, v81, v13
  v_mul_f32 v82, v82, v13
  v_mul_f32 v83, v83, v13
  v_mul_f32 v84, v84, v13
  v_mul_f32 v85, v85, v13
  v_mul_f32 v86, v86, v13
  v_mul_f32 v87, v87, v13
  v_cvt_pk_bf16_f32 v136, v80, v81
  v_cvt_pk_bf16_f32 v137, v82, v83
  v_cvt_pk_bf16_f32 v138, v84, v85
  v_cvt_pk_bf16_f32 v139, v86, v87
  buffer_store_dwordx4 v[136:139], v2, s[8:11], s36 offen sc1
  v_and_b32 v11, 1, v1
  v_lshlrev_b32 v11, 1, v11
  v_bfe_u32 v10, v1, 1, 1
  v_or_b32 v10, v10, v11
  v_lshlrev_b32 v10, 3, v10
  v_bfe_u32 v11, v1, 3, 1
  v_lshl_or_b32 v10, v11, 6, v10
  v_bfe_u32 v11, v1, 2, 2
  v_lshl_or_b32 v10, v11, 7, v10
  v_lshrrev_b32 v11, 5, v1
  v_lshl_or_b32 v10, v11, 10, v10
  v_bfe_u32 v12, v1, 4, 1
  v_lshl_or_b32 v9, v12, 5, v10
  s_lshl_b32 s26, s25, 6
  v_xor_b32 v10, s26, v9
  s_mul_i32 s27, s25, 20480
  s_add_u32 s27, s27, 24576
  v_add_u32 v10, s27, v10
  v_xor_b32 v11, 64, v10
  v_mov_b32 v12, s56
  v_mov_b32 v13, s57
  s_barrier
  ds_read_b64_tr_b16 v[176:177], v10 offset:0
  ds_read_b64_tr_b16 v[178:179], v10 offset:512
  ds_read_b64_tr_b16 v[180:181], v11 offset:0
  ds_read_b64_tr_b16 v[182:183], v11 offset:512
  ds_read_b64_tr_b16 v[184:185], v10 offset:2048
  ds_read_b64_tr_b16 v[186:187], v10 offset:2560
  ds_read_b64_tr_b16 v[188:189], v11 offset:2048
  ds_read_b64_tr_b16 v[190:191], v11 offset:2560
  ds_read_b64_tr_b16 v[192:193], v10 offset:4096
  ds_read_b64_tr_b16 v[194:195], v10 offset:4608
  s_waitcnt vmcnt(6)
  ds_read_b64_tr_b16 v[196:197], v11 offset:4096
  ds_read_b64_tr_b16 v[198:199], v11 offset:4608
  ds_read_b64_tr_b16 v[200:201], v10 offset:6144
  ds_read_b64_tr_b16 v[202:203], v10 offset:6656
  ds_read_b64_tr_b16 v[204:205], v11 offset:6144
  ds_read_b64_tr_b16 v[206:207], v11 offset:6656
  ds_read_b64_tr_b16 v[208:209], v10 offset:8192
  ds_read_b64_tr_b16 v[210:211], v10 offset:8704
  ds_read_b64_tr_b16 v[212:213], v11 offset:8192
  ds_read_b64_tr_b16 v[214:215], v11 offset:8704
  ds_read_b64_tr_b16 v[216:217], v10 offset:10240
  ds_read_b64_tr_b16 v[218:219], v10 offset:10752
  ds_read_b64_tr_b16 v[220:221], v11 offset:10240
  ds_read_b64_tr_b16 v[222:223], v11 offset:10752
  ds_read_b64_tr_b16 v[224:225], v10 offset:12288
  ds_read_b64_tr_b16 v[226:227], v10 offset:12800
  ds_read_b64_tr_b16 v[228:229], v11 offset:12288
  ds_read_b64_tr_b16 v[230:231], v11 offset:12800
  ds_read_b64_tr_b16 v[232:233], v10 offset:14336
  ds_read_b64_tr_b16 v[234:235], v10 offset:14848
  ds_read_b64_tr_b16 v[236:237], v11 offset:14336
  ds_read_b64_tr_b16 v[238:239], v11 offset:14848
  ds_read_b64_tr_b16 v[240:241], v10 offset:16384
  ds_read_b64_tr_b16 v[242:243], v10 offset:16896
  ds_read_b64_tr_b16 v[244:245], v11 offset:16384
  ds_read_b64_tr_b16 v[246:247], v11 offset:16896
  ds_read_b64_tr_b16 v[248:249], v10 offset:18432
  ds_read_b64_tr_b16 v[250:251], v10 offset:18944
  ds_read_b64_tr_b16 v[252:253], v11 offset:18432
  ds_read_b64_tr_b16 v[254:255], v11 offset:18944
  s_mov_b32 s26, s39
  s_mov_b32 s30, s6
  s_lshl_b32 s34, s4, 2
  s_add_u32 s34, s34, s7
  s_lshl_b32 s30, s30, 3
  s_lshl_b32 s27, s3, 1
  s_add_u32 s30, s30, s27
  s_lshl_b32 s28, s34, 16
  s_lshl_b32 s33, s30, 5
  s_add_u32 s33, s33, s34
  s_lshl_b32 s33, s33, 10
  s_add_u32 s33, s33, 0xc00000
  s_add_u32 s34, s33, 0x8000
  s_lshl_b32 s35, s4, 2
  s_add_u32 s35, s35, s7
  s_lshl_b32 s35, s35, 9
  s_add_u32 s35, s35, 0x2024000
  v_and_b32 v112, 27, v1
  v_cmp_eq_u32 vcc, 16, v112
  v_mov_b32 v114, 0x3f803f80
  s_nop 0
  v_cndmask_b32 v144, 0, v114, vcc
  v_mov_b32 v145, v144
  v_mov_b32 v146, v144
  v_mov_b32 v147, v144
  v_mov_b32 v148, v144
  v_mov_b32 v149, v144
  v_mov_b32 v150, v144
  v_mov_b32 v151, v144
  v_mov_b32 v152, v144
  v_mov_b32 v153, v144
  v_mov_b32 v154, v144
  v_mov_b32 v155, v144
  v_mov_b32 v156, v144
  v_mov_b32 v157, v144
  v_mov_b32 v158, v144
  v_mov_b32 v159, v144
  v_mov_b32 v160, v144
  v_mov_b32 v161, v144
  v_mov_b32 v162, v144
  v_mov_b32 v163, v144
  v_mov_b32 v164, v144
  v_mov_b32 v165, v144
  v_mov_b32 v166, v144
  v_mov_b32 v167, v144
  v_mov_b32 v168, v144
  v_mov_b32 v169, v144
  v_mov_b32 v170, v144
  v_mov_b32 v171, v144
  v_mov_b32 v172, v144
  v_mov_b32 v173, v144
  v_mov_b32 v174, v144
  v_mov_b32 v175, v144
  s_mov_b32 s50, 0xffff
  s_mov_b32 s51, 0xffff
  s_lshl_b32 s27, s3, 8
  s_add_u32 s27, s27, 155648
  v_lshl_add_u32 v5, v1, 2, s27
  v_add_u32 v4, 0x10000, v15
  s_lshl_b32 s31, s4, 2
  s_add_u32 s31, s31, s7
  s_lshl_b32 s31, s31, 1
  s_add_u32 s31, s31, s24
  s_lshl_b32 s32, s6, 1
  s_add_u32 s32, s32, s25
  s_lshl_b32 s47, s31, 15
  s_lshl_b32 s36, s25, 14
  s_add_u32 s36, s36, s47
  s_add_u32 s36, s36, 0xc00000
  s_add_u32 s37, s36, 0x1000
  s_add_u32 s38, s36, 0x2000
  s_add_u32 s39, s36, 0x3000
  s_lshl_b32 s40, s32, 6
  s_add_u32 s40, s40, s47
  s_mov_b32 s41, 0xfffffffe
  s_mov_b32 s42, 15
  s_mul_i32 s47, s31, 33792
  s_lshl_b32 s43, s32, 11
  s_add_u32 s43, s43, s47
  s_add_u32 s43, s43, 0x1a00000
  s_lshl_b32 s44, s31, 12
  s_lshl_b32 s47, s6, 9
  s_add_u32 s44, s44, s47
  s_lshl_b32 s47, s25, 3
  s_add_u32 s44, s44, s47
  s_add_u32 s44, s44, 0x1000000
  s_lshl_b32 s45, s31, 7
  s_lshl_b32 s47, s32, 3
  s_add_u32 s45, s45, s47
  s_add_u32 s45, s45, 0x2028000
  s_lshl_b32 s31, s4, 3
  s_add_u32 s31, s31, s3
  s_lshl_b32 s46, s31, 7
  s_add_u32 s46, s46, 0x2028000
  s_and_b32 s32, s5, 1
  s_sub_u32 s20, 0, s32
  s_mov_b32 s21, s20
  s_lshl_b32 s32, s32, 2
  s_add_u32 s31, s31, s32
  s_mul_i32 s47, s31, 33792
  s_add_u32 s47, s47, 0x1a00000
  s_lshl_b32 s22, s31, 12
  s_add_u32 s22, s22, 0x1000000
  s_lshr_b32 s23, s5, 3
  s_bfe_u32 s32, s5, 0x20001
  s_mul_i32 s16, s23, 29
  s_add_u32 s16, s16, s32
  s_mul_i32 s18, s24, 28
  s_add_u32 s18, s18, s32
  s_lshl_b32 s18, s18, 3
  s_lshl_b32 s23, s23, 9
  s_add_u32 s18, s18, s23
  s_add_u32 s18, s18, 0x202c000
  s_xor_b32 s32, s31, 4
  s_mul_i32 s17, s32, 116
  s_add_u32 s17, s17, s16
  s_lshl_b32 s17, s17, 10
  s_add_u32 s17, s17, 0x1204000
  s_mul_i32 s23, s31, 116
  s_add_u32 s16, s16, s23
  s_lshl_b32 s16, s16, 10
  s_add_u32 s16, s16, 0x1200000
  s_lshr_b32 s19, s32, 1
  s_lshl_b32 s19, s19, 11
  s_add_u32 s19, s19, s18
  s_add_u32 s19, s19, 128
  s_lshr_b32 s23, s31, 1
  s_lshl_b32 s23, s23, 11
  s_add_u32 s18, s18, s23
  s_mul_i32 s31, s32, 33792
  s_add_u32 s31, s31, 0x1a00000
  v_mov_b32 v7, v9
  s_lshl_b32 s27, s3, 11
  s_add_u32 s27, s27, 122880
  v_add_u32 v120, s27, v2
  v_mov_b32 v3, v2
  s_mov_b32 s49, 3
  s_mov_b32 s48, 0xf7ffffff
  v_mov_b32 v122, s56
  v_mov_b32 v123, s57
  s_waitcnt vmcnt(0)
  buffer_store_dwordx2 v[122:123], off, s[8:11], s26 sc1
  s_waitcnt lgkmcnt(0)
  s_barrier
  ds_read_b128 v[8:11], v120 offset:0
  ds_read_b128 v[12:15], v120 offset:1024
  ds_read_b128 v[128:131], v3 offset:0
  ds_read_b128 v[132:135], v3 offset:1024
  s_mov_b64 exec, s[50:51]
  ds_read_b128 v[144:147], v4 offset:0
  ds_read_b128 v[148:151], v4 offset:512
  ds_read_b128 v[152:155], v4 offset:1024
  ds_read_b128 v[156:159], v4 offset:1536
  s_mov_b64 exec, -1
  v_mov_b32 v48, 0
  v_mov_b32 v49, 0
  v_mov_b32 v50, 0
  v_mov_b32 v51, 0
  v_mov_b32 v52, 0
  v_mov_b32 v53, 0
  v_mov_b32 v54, 0
  v_mov_b32 v55, 0
  v_mov_b32 v56, 0
  v_mov_b32 v57, 0
  v_mov_b32 v58, 0
  v_mov_b32 v59, 0
  v_mov_b32 v60, 0
  v_mov_b32 v61, 0
  v_mov_b32 v62, 0
  v_mov_b32 v63, 0
  v_mov_b32 v64, 0
  v_mov_b32 v65, 0
  v_mov_b32 v66, 0
  v_mov_b32 v67, 0
  v_mov_b32 v68, 0
  v_mov_b32 v69, 0
  v_mov_b32 v70, 0
  v_mov_b32 v71, 0
  v_mov_b32 v72, 0
  v_mov_b32 v73, 0
  v_mov_b32 v74, 0
  v_mov_b32 v75, 0
  v_mov_b32 v76, 0
  v_mov_b32 v77, 0
  v_mov_b32 v78, 0
  v_mov_b32 v79, 0
  s_waitcnt lgkmcnt(5)
  v_mfma_f32_32x32x16_bf16 v[80:95], v[128:131], v[8:11], 0
  v_mfma_f32_32x32x16_bf16 v[96:111], v[128:131], v[12:15], 0
  s_nop 10
  v_max3_f32 v115, v80, v81, v82
  v_max3_f32 v117, v83, v84, v85
  v_max3_f32 v115, v115, v86, v87
  v_max3_f32 v117, v117, v88, v89
  v_max3_f32 v115, v115, v90, v91
  v_max3_f32 v117, v117, v92, v93
  v_max3_f32 v115, v115, v94, v95
  v_max_f32 v115, v115, v117
  v_mov_b32 v114, v115
  s_nop 1
  v_permlane32_swap_b32 v114, v115
  v_max_f32 v115, v115, v114
  v_sub_f32 v16, 0, v115
  v_mov_b32 v17, v16
  v_mov_b32 v18, v16
  v_mov_b32 v19, v16
  v_mov_b32 v20, v16
  v_mov_b32 v21, v16
  v_mov_b32 v22, v16
  v_mov_b32 v23, v16
  v_mov_b32 v24, v16
  v_mov_b32 v25, v16
  v_mov_b32 v26, v16
  v_mov_b32 v27, v16
  v_mov_b32 v28, v16
  v_mov_b32 v29, v16
  v_mov_b32 v30, v16
  v_mov_b32 v31, v16
  s_nop 1
  v_mfma_f32_32x32x16_bf16 v[80:95], v[128:131], v[8:11], v[16:31]
  v_max3_f32 v116, v96, v97, v98
  v_max3_f32 v117, v99, v100, v101
  v_max3_f32 v116, v116, v102, v103
  v_max3_f32 v117, v117, v104, v105
  v_max3_f32 v116, v116, v106, v107
  v_max3_f32 v117, v117, v108, v109
  v_max3_f32 v116, v116, v110, v111
  v_max_f32 v116, v116, v117
  v_mov_b32 v114, v116
  s_nop 1
  v_permlane32_swap_b32 v114, v116
  v_max_f32 v116, v116, v114
  v_sub_f32 v32, 0, v116
  v_mov_b32 v33, v32
  v_mov_b32 v34, v32
  v_mov_b32 v35, v32
  v_mov_b32 v36, v32
  v_mov_b32 v37, v32
  v_mov_b32 v38, v32
  v_mov_b32 v39, v32
  v_mov_b32 v40, v32
  v_mov_b32 v41, v32
  v_mov_b32 v42, v32
  v_mov_b32 v43, v32
  v_mov_b32 v44, v32
  v_mov_b32 v45, v32
  v_mov_b32 v46, v32
  v_mov_b32 v47, v32
  v_mov_b32 v124, 0
  v_mov_b32 v125, 0
  v_mov_b32 v126, 0
  v_mov_b32 v127, 0
  .p2align 6
LOOP_kz_ker_5:
  v_mfma_f32_32x32x16_bf16 v[96:111], v[128:131], v[12:15], v[32:47]
  v_exp_f32 v80, v80
  v_exp_f32 v81, v81
  v_exp_f32 v82, v82
  v_exp_f32 v83, v83
  v_mfma_f32_32x32x16_bf16 v[64:79], v[172:175], v[124:127], v[64:79]
  ds_read_b128 v[136:139], v3 offset:2048
  v_exp_f32 v84, v84
  v_exp_f32 v85, v85
  v_exp_f32 v86, v86
  v_exp_f32 v87, v87
  v_cvt_pk_bf16_f32 v112, v80, v81
  v_cvt_pk_bf16_f32 v113, v82, v83
  v_cvt_pk_bf16_f32 v114, v84, v85
  v_cvt_pk_bf16_f32 v115, v86, v87
  v_exp_f32 v88, v88
  v_exp_f32 v89, v89
  v_exp_f32 v90, v90
  v_exp_f32 v91, v91
  s_waitcnt lgkmcnt(4)
  v_mfma_f32_32x32x16_bf16 v[48:63], v[144:147], v[112:115], v[48:63]
  v_exp_f32 v92, v92
  v_exp_f32 v93, v93
  v_exp_f32 v94, v94
  v_exp_f32 v95, v95
  v_cvt_pk_bf16_f32 v116, v88, v89
  v_cvt_pk_bf16_f32 v117, v90, v91
  v_cvt_pk_bf16_f32 v118, v92, v93
  v_cvt_pk_bf16_f32 v119, v94, v95
  s_waitcnt lgkmcnt(1)
  v_mfma_f32_32x32x16_bf16 v[80:95], v[132:135], v[8:11], v[16:31]
  v_exp_f32 v96, v96
  v_exp_f32 v97, v97
  v_exp_f32 v98, v98
  v_exp_f32 v99, v99
  v_mfma_f32_32x32x16_bf16 v[48:63], v[148:151], v[116:119], v[48:63]
  s_mov_b64 exec, s[50:51]
  ds_read_b128 v[160:163], v4 offset:2048
  ds_read_b128 v[164:167], v4 offset:2560
  ds_read_b128 v[168:171], v4 offset:3072
  ds_read_b128 v[172:175], v4 offset:3584
  s_mov_b64 exec, -1
  v_exp_f32 v100, v100
  v_exp_f32 v101, v101
  v_exp_f32 v102, v102
  v_exp_f32 v103, v103
  v_cvt_pk_bf16_f32 v120, v96, v97
  v_cvt_pk_bf16_f32 v121, v98, v99
  v_cvt_pk_bf16_f32 v122, v100, v101
  v_cvt_pk_bf16_f32 v123, v102, v103
  v_exp_f32 v104, v104
  v_exp_f32 v105, v105
  v_exp_f32 v106, v106
  v_exp_f32 v107, v107
  v_mfma_f32_32x32x16_bf16 v[64:79], v[144:147], v[120:123], v[64:79]
  v_exp_f32 v108, v108
  v_exp_f32 v109, v109
  v_exp_f32 v110, v110
  v_exp_f32 v111, v111
  v_cvt_pk_bf16_f32 v124, v104, v105
  v_cvt_pk_bf16_f32 v125, v106, v107
  v_cvt_pk_bf16_f32 v126, v108, v109
  v_cvt_pk_bf16_f32 v127, v110, v111
  v_mfma_f32_32x32x16_bf16 v[96:111], v[132:135], v[12:15], v[32:47]
  v_exp_f32 v80, v80
  v_exp_f32 v81, v81
  v_exp_f32 v82, v82
  v_exp_f32 v83, v83
  v_mfma_f32_32x32x16_bf16 v[64:79], v[148:151], v[124:127], v[64:79]
  ds_read_b128 v[140:143], v3 offset:3072
  ds_read_b32 v6, v5 offset:1024
  v_exp_f32 v84, v84
  v_exp_f32 v85, v85
  v_exp_f32 v86, v86
  v_exp_f32 v87, v87
  v_cvt_pk_bf16_f32 v112, v80, v81
  v_cvt_pk_bf16_f32 v113, v82, v83
  v_cvt_pk_bf16_f32 v114, v84, v85
  v_cvt_pk_bf16_f32 v115, v86, v87
  v_exp_f32 v88, v88
  v_exp_f32 v89, v89
  v_exp_f32 v90, v90
  v_exp_f32 v91, v91
  v_mfma_f32_32x32x16_bf16 v[48:63], v[152:155], v[112:115], v[48:63]
  v_exp_f32 v92, v92
  v_exp_f32 v93, v93
  v_exp_f32 v94, v94
  v_exp_f32 v95, v95
  v_cvt_pk_bf16_f32 v116, v88, v89
  v_cvt_pk_bf16_f32 v117, v90, v91
  v_cvt_pk_bf16_f32 v118, v92, v93
  v_cvt_pk_bf16_f32 v119, v94, v95
  s_waitcnt lgkmcnt(6)
  v_mfma_f32_32x32x16_bf16 v[80:95], v[136:139], v[8:11], v[16:31]
  v_exp_f32 v96, v96
  v_exp_f32 v97, v97
  v_exp_f32 v98, v98
  v_exp_f32 v99, v99
  v_mfma_f32_32x32x16_bf16 v[48:63], v[156:159], v[116:119], v[48:63]
  v_exp_f32 v100, v100
  v_exp_f32 v101, v101
  v_exp_f32 v102, v102
  v_exp_f32 v103, v103
  v_cvt_pk_bf16_f32 v120, v96, v97
  v_cvt_pk_bf16_f32 v121, v98, v99
  v_cvt_pk_bf16_f32 v122, v100, v101
  v_cvt_pk_bf16_f32 v123, v102, v103
  s_waitcnt lgkmcnt(0)
  v_readfirstlane_b32 s52, v6
  v_exp_f32 v104, v104
  v_exp_f32 v105, v105
  v_exp_f32 v106, v106
  v_exp_f32 v107, v107
  v_mfma_f32_32x32x16_bf16 v[64:79], v[152:155], v[120:123], v[64:79]
  s_and_b32 s52, s52, s48
  v_exp_f32 v108, v108
  v_exp_f32 v109, v109
  v_exp_f32 v110, v110
  v_exp_f32 v111, v111
  v_cvt_pk_bf16_f32 v124, v104, v105
  v_cvt_pk_bf16_f32 v125, v106, v107
  v_cvt_pk_bf16_f32 v126, v108, v109
  v_cvt_pk_bf16_f32 v127, v110, v111
  v_mfma_f32_32x32x16_bf16 v[96:111], v[136:139], v[12:15], v[32:47]
  ds_write_b32 v5, v3
  s_bitcmp1_b32 s52, s49
  s_cbranch_scc0 OOL_kz_ker_8
BACK_kz_ker_9:
  v_exp_f32 v80, v80
  v_exp_f32 v81, v81
  v_exp_f32 v82, v82
  v_exp_f32 v83, v83
  v_mfma_f32_32x32x16_bf16 v[64:79], v[156:159], v[124:127], v[64:79]
  ds_read_b128 v[128:131], v3 offset:4096
  v_exp_f32 v84, v84
  v_exp_f32 v85, v85
  v_exp_f32 v86, v86
  v_exp_f32 v87, v87
  v_cvt_pk_bf16_f32 v112, v80, v81
  v_cvt_pk_bf16_f32 v113, v82, v83
  v_cvt_pk_bf16_f32 v114, v84, v85
  v_cvt_pk_bf16_f32 v115, v86, v87
  v_exp_f32 v88, v88
  v_exp_f32 v89, v89
  v_exp_f32 v90, v90
  v_exp_f32 v91, v91
  v_mfma_f32_32x32x16_bf16 v[48:63], v[160:163], v[112:115], v[48:63]
  v_exp_f32 v92, v92
  v_exp_f32 v93, v93
  v_exp_f32 v94, v94
  v_exp_f32 v95, v95
  v_cvt_pk_bf16_f32 v116, v88, v89
  v_cvt_pk_bf16_f32 v117, v90, v91
  v_cvt_pk_bf16_f32 v118, v92, v93
  v_cvt_pk_bf16_f32 v119, v94, v95
  v_mfma_f32_32x32x16_bf16 v[80:95], v[140:143], v[8:11], v[16:31]
  v_exp_f32 v96, v96
  v_exp_f32 v97, v97
  v_exp_f32 v98, v98
  v_exp_f32 v99, v99
  v_mfma_f32_32x32x16_bf16 v[48:63], v[164:167], v[116:119], v[48:63]
  s_mov_b64 exec, s[50:51]
  ds_read_b128 v[144:147], v4 offset:4096
  ds_read_b128 v[148:151], v4 offset:4608
  ds_read_b128 v[152:155], v4 offset:5120
  ds_read_b128 v[156:159], v4 offset:5632
  s_mov_b64 exec, -1
  v_exp_f32 v100, v100
  v_exp_f32 v101, v101
  v_exp_f32 v102, v102
  v_exp_f32 v103, v103
  v_cvt_pk_bf16_f32 v120, v96, v97
  v_cvt_pk_bf16_f32 v121, v98, v99
  v_cvt_pk_bf16_f32 v122, v100, v101
  v_cvt_pk_bf16_f32 v123, v102, v103
  v_exp_f32 v104, v104
  v_exp_f32 v105, v105
  v_exp_f32 v106, v106
  v_exp_f32 v107, v107
  v_mfma_f32_32x32x16_bf16 v[64:79], v[160:163], v[120:123], v[64:79]
  v_exp_f32 v108, v108
  v_exp_f32 v109, v109
  v_exp_f32 v110, v110
  v_exp_f32 v111, v111
  v_cvt_pk_bf16_f32 v124, v104, v105
  v_cvt_pk_bf16_f32 v125, v106, v107
  v_cvt_pk_bf16_f32 v126, v108, v109
  v_cvt_pk_bf16_f32 v127, v110, v111
  v_mfma_f32_32x32x16_bf16 v[96:111], v[140:143], v[12:15], v[32:47]
  v_exp_f32 v80, v80
  v_exp_f32 v81, v81
  v_exp_f32 v82, v82
  v_exp_f32 v83, v83
  v_mfma_f32_32x32x16_bf16 v[64:79], v[164:167], v[124:127], v[64:79]
  ds_read_b128 v[132:135], v3 offset:5120
  v_exp_f32 v84, v84
  v_exp_f32 v85, v85
  v_exp_f32 v86, v86
  v_exp_f32 v87, v87
  v_cvt_pk_bf16_f32 v112, v80, v81
  v_cvt_pk_bf16_f32 v113, v82, v83
  v_cvt_pk_bf16_f32 v114, v84, v85
  v_cvt_pk_bf16_f32 v115, v86, v87
  v_exp_f32 v88, v88
  v_exp_f32 v89, v89
  v_exp_f32 v90, v90
  v_exp_f32 v91, v91
  v_mfma_f32_32x32x16_bf16 v[48:63], v[168:171], v[112:115], v[48:63]
  v_exp_f32 v92, v92
  v_exp_f32 v93, v93
  v_exp_f32 v94, v94
  v_exp_f32 v95, v95
  v_cvt_pk_bf16_f32 v116, v88, v89
  v_cvt_pk_bf16_f32 v117, v90, v91
  v_cvt_pk_bf16_f32 v118, v92, v93
  v_cvt_pk_bf16_f32 v119, v94, v95
  s_waitcnt lgkmcnt(5)
  v_mfma_f32_32x32x16_bf16 v[80:95], v[128:131], v[8:11], v[16:31]
  v_exp_f32 v96, v96
  v_exp_f32 v97, v97
  v_exp_f32 v98, v98
  v_exp_f32 v99, v99
  v_mfma_f32_32x32x16_bf16 v[48:63], v[172:175], v[116:119], v[48:63]
  v_exp_f32 v100, v100
  v_exp_f32 v101, v101
  v_exp_f32 v102, v102
  v_exp_f32 v103, v103
  v_cvt_pk_bf16_f32 v120, v96, v97
  v_cvt_pk_bf16_f32 v121, v98, v99
  v_cvt_pk_bf16_f32 v122, v100, v101
  v_cvt_pk_bf16_f32 v123, v102, v103
  v_exp_f32 v104, v104
  v_exp_f32 v105, v105
  v_exp_f32 v106, v106
  v_exp_f32 v107, v107
  v_mfma_f32_32x32x16_bf16 v[64:79], v[168:171], v[120:123], v[64:79]
  s_add_u32 s49, s49, 2
  s_cmp_lg_u32 s49, 35
  v_exp_f32 v108, v108
  v_exp_f32 v109, v109
  v_exp_f32 v110, v110
  v_exp_f32 v111, v111
  v_cvt_pk_bf16_f32 v124, v104, v105
  v_cvt_pk_bf16_f32 v125, v106, v107
  v_cvt_pk_bf16_f32 v126, v108, v109
  v_cvt_pk_bf16_f32 v127, v110, v111
  v_add_u32 v3, 0x1000, v3
  v_add_u32 v4, 0x1000, v4
  s_cbranch_scc1 LOOP_kz_ker_5
  v_mfma_f32_32x32x16_bf16 v[64:79], v[172:175], v[124:127], v[64:79]
  s_mov_b32 s53, 0x53800000
  s_nop 10
  v_max_f32 v3, v56, v72
  v_cmp_u_f32 s[54:55], v56, v72
  v_cmp_nlt_f32 vcc, v3, s53
  s_or_b64 vcc, vcc, s[54:55]
  s_cbranch_vccnz SLOW_kz_ker_6
FIN_kz_ker_7:
  s_waitcnt vmcnt(0)
  v_cmp_eq_u64 vcc, s[58:59], v[0:1]
  s_cmp_eq_u32 vcc_hi, -1
  s_cselect_b32 s61, 1, 0
  v_rcp_f32 v3, v56
  s_nop 0
  v_mul_f32 v48, v48, v3
  v_mul_f32 v49, v49, v3
  v_mul_f32 v50, v50, v3
  v_mul_f32 v51, v51, v3
  v_mul_f32 v52, v52, v3
  v_mul_f32 v53, v53, v3
  v_mul_f32 v54, v54, v3
  v_mul_f32 v55, v55, v3
  v_cvt_pk_bf16_f32 v8, v48, v49
  v_cvt_pk_bf16_f32 v9, v50, v51
  v_cvt_pk_bf16_f32 v10, v52, v53
  v_cvt_pk_bf16_f32 v11, v54, v55
  buffer_store_dwordx4 v[8:11], v2, s[8:11], s33 offen sc1
  v_rcp_f32 v3, v72
  s_nop 0
  v_mul_f32 v64, v64, v3
  v_mul_f32 v65, v65, v3
  v_mul_f32 v66, v66, v3
  v_mul_f32 v67, v67, v3
  v_mul_f32 v68, v68, v3
  v_mul_f32 v69, v69, v3
  v_mul_f32 v70, v70, v3
  v_mul_f32 v71, v71, v3
  v_cvt_pk_bf16_f32 v12, v64, v65
  v_cvt_pk_bf16_f32 v13, v66, v67
  v_cvt_pk_bf16_f32 v14, v68, v69
  v_cvt_pk_bf16_f32 v15, v70, v71
  buffer_store_dwordx4 v[12:15], v2, s[8:11], s34 offen sc1
  s_waitcnt vmcnt(0)
  v_and_b32 v0, -16, v0
  v_cmp_eq_u64 vcc, s[56:57], v[0:1]
  s_andn2_b64 s[62:63], -1, vcc
  s_cmp_eq_u64 s[62:63], 0
  s_cbranch_scc0 PR_kz_ker_10
PRB_kz_ker_11:
  v_bfe_u32 v168, v2, 4, 4
  v_lshlrev_b32 v168, 10, v168
  v_and_b32 v8, 0x1f0, v2
  v_lshrrev_b32 v6, 5, v2
  v_and_b32 v6, 16, v6
  v_lshl_or_b32 v5, v8, 6, v6
  buffer_load_dwordx4 v[160:163], v5, s[12:15], s40 offen
  buffer_load_dwordx4 v[164:167], v5, s[12:15], s40 offen offset:32
  s_lshl_b32 s26, s25, 6
  s_mul_i32 s27, s25, 12288
  s_add_u32 s27, s27, 131072
  v_xor_b32 v3, s26, v7
  v_add_u32 v3, s27, v3
  v_xor_b32 v4, 64, v3
  ds_read_b64_tr_b16 v[80:81], v3 offset:0
  ds_read_b64_tr_b16 v[82:83], v3 offset:512
  ds_read_b64_tr_b16 v[84:85], v4 offset:0
  ds_read_b64_tr_b16 v[86:87], v4 offset:512
  ds_read_b64_tr_b16 v[88:89], v3 offset:2048
  ds_read_b64_tr_b16 v[90:91], v3 offset:2560
  ds_read_b64_tr_b16 v[92:93], v4 offset:2048
  ds_read_b64_tr_b16 v[94:95], v4 offset:2560
  ds_read_b64_tr_b16 v[96:97], v3 offset:4096
  ds_read_b64_tr_b16 v[98:99], v3 offset:4608
  ds_read_b64_tr_b16 v[100:101], v4 offset:4096
  ds_read_b64_tr_b16 v[102:103], v4 offset:4608
  ds_read_b64_tr_b16 v[104:105], v3 offset:6144
  ds_read_b64_tr_b16 v[106:107], v3 offset:6656
  ds_read_b64_tr_b16 v[108:109], v4 offset:6144
  ds_read_b64_tr_b16 v[110:111], v4 offset:6656
  ds_read_b64_tr_b16 v[112:113], v3 offset:8192
  ds_read_b64_tr_b16 v[114:115], v3 offset:8704
  ds_read_b64_tr_b16 v[116:117], v4 offset:8192
  ds_read_b64_tr_b16 v[118:119], v4 offset:8704
  ds_read_b64_tr_b16 v[120:121], v3 offset:10240
  ds_read_b64_tr_b16 v[122:123], v3 offset:10752
  ds_read_b64_tr_b16 v[124:125], v4 offset:10240
  ds_read_b64_tr_b16 v[126:127], v4 offset:10752
  v_mov_b32 v128, 0
  v_mov_b32 v129, 0
  v_mov_b32 v130, 0
  v_mov_b32 v131, 0
  s_waitcnt lgkmcnt(15)
  v_mov_b32 v132, 0
  v_mov_b32 v133, 0
  v_mov_b32 v134, 0
  v_mov_b32 v135, 0
  v_mov_b32 v136, 0
  v_mov_b32 v137, 0
  v_mov_b32 v138, 0
  v_mov_b32 v139, 0
  v_mov_b32 v140, 0
  v_mov_b32 v141, 0
  v_mov_b32 v142, 0
  v_mov_b32 v143, 0
  v_mov_b32 v144, 0
  v_mov_b32 v145, 0
  v_mov_b32 v146, 0
  v_mov_b32 v147, 0
  v_mov_b32 v148, 0
  v_mov_b32 v149, 0
  v_mov_b32 v150, 0
  v_mov_b32 v151, 0
  v_mov_b32 v152, 0
  v_mov_b32 v153, 0
  v_mov_b32 v154, 0
  v_mov_b32 v155, 0
  v_mov_b32 v156, 0
  v_mov_b32 v157, 0
  v_mov_b32 v158, 0
  v_mov_b32 v159, 0
  v_add_u32 v12, 0x10000, v2
  v_add_u32 v13, 0x400, v2
  v_add_u32 v14, 0x400, v12
  v_lshl_or_b32 v9, v6, 7, v8
  v_lshrrev_b32 v6, 1, v2
  v_and_b32 v6, 0x78, v6
  v_and_b32 v10, 0x100, v2
  v_lshl_or_b32 v6, v10, 1, v6
  s_lshl_b32 s26, s3, 12
  s_add_u32 s26, s26, 131072
  v_add_u32 v10, s26, v2
  v_xor_b32 v11, 0x2000, v10
  v_mov_b32 v0, s56
  v_mov_b32 v1, s57
  s_waitcnt lgkmcnt(0)
  s_barrier
  buffer_load_dwordx4 v[16:19], v2, s[8:11], s36 offen offset:0 sc1
  buffer_load_dwordx4 v[20:23], v2, s[8:11], s36 offen offset:1024 sc1
  buffer_load_dwordx4 v[24:27], v2, s[8:11], s36 offen offset:2048 sc1
  buffer_load_dwordx4 v[28:31], v2, s[8:11], s36 offen offset:3072 sc1
  buffer_load_dwordx4 v[32:35], v2, s[8:11], s37 offen offset:0 sc1
  buffer_load_dwordx4 v[36:39], v2, s[8:11], s37 offen offset:1024 sc1
  buffer_load_dwordx4 v[40:43], v2, s[8:11], s37 offen offset:2048 sc1
  buffer_load_dwordx4 v[44:47], v2, s[8:11], s37 offen offset:3072 sc1
  buffer_load_dwordx4 v[48:51], v2, s[8:11], s38 offen offset:0 sc1
  buffer_load_dwordx4 v[52:55], v2, s[8:11], s38 offen offset:1024 sc1
  buffer_load_dwordx4 v[56:59], v2, s[8:11], s38 offen offset:2048 sc1
  buffer_load_dwordx4 v[60:63], v2, s[8:11], s38 offen offset:3072 sc1
  buffer_load_dwordx4 v[64:67], v2, s[8:11], s39 offen offset:0 sc1
  buffer_load_dwordx4 v[68:71], v2, s[8:11], s39 offen offset:1024 sc1
  buffer_load_dwordx4 v[72:75], v2, s[8:11], s39 offen offset:2048 sc1
  buffer_load_dwordx4 v[76:79], v2, s[8:11], s39 offen offset:3072 sc1
P3L_kz_ker_12:
  s_bitcmp1_b32 s42, 0
  s_cbranch_scc0 SK_kz_ker_14
  s_waitcnt vmcnt(15)
  v_max3_u32 v3, v16, v17, v18
  s_waitcnt vmcnt(14)
  v_max3_u32 v4, v19, v20, v21
  v_max3_u32 v3, v3, v22, v23
  s_waitcnt vmcnt(13)
  v_max3_u32 v4, v4, v24, v25
  v_max3_u32 v3, v3, v26, v27
  s_waitcnt vmcnt(12)
  v_max3_u32 v4, v4, v28, v29
  v_max3_u32 v3, v3, v30, v31
  v_max_u32 v3, v3, v4
  v_cmp_lt_u32 vcc, s41, v3
  s_nop 4
  s_cbranch_vccnz FL_kz_ker_15
  v_mfma_f32_32x32x16_bf16 v[128:143], v[176:179], v[16:19], v[128:143]
  v_mfma_f32_32x32x16_bf16 v[144:159], v[180:183], v[16:19], v[144:159]
  v_mfma_f32_32x32x16_bf16 v[128:143], v[184:187], v[20:23], v[128:143]
  v_mfma_f32_32x32x16_bf16 v[144:159], v[188:191], v[20:23], v[144:159]
  v_mfma_f32_32x32x16_bf16 v[128:143], v[192:195], v[24:27], v[128:143]
  v_mfma_f32_32x32x16_bf16 v[144:159], v[196:199], v[24:27], v[144:159]
  v_mfma_f32_32x32x16_bf16 v[128:143], v[200:203], v[28:31], v[128:143]
  v_mfma_f32_32x32x16_bf16 v[144:159], v[204:207], v[28:31], v[144:159]
  s_bitset0_b32 s42, 0
SK_kz_ker_14:
  s_bitcmp1_b32 s42, 1
  s_cbranch_scc0 SK_kz_ker_16
  s_waitcnt vmcnt(11)
  v_max3_u32 v3, v32, v33, v34
  s_waitcnt vmcnt(10)
  v_max3_u32 v4, v35, v36, v37
  v_max3_u32 v3, v3, v38, v39
  s_waitcnt vmcnt(9)
  v_max3_u32 v4, v4, v40, v41
  v_max3_u32 v3, v3, v42, v43
  s_waitcnt vmcnt(8)
  v_max3_u32 v4, v4, v44, v45
  v_max3_u32 v3, v3, v46, v47
  v_max_u32 v3, v3, v4
  v_cmp_lt_u32 vcc, s41, v3
  s_nop 4
  s_cbranch_vccnz FL_kz_ker_17
  v_mfma_f32_32x32x16_bf16 v[128:143], v[208:211], v[32:35], v[128:143]
  v_mfma_f32_32x32x16_bf16 v[144:159], v[212:215], v[32:35], v[144:159]
  v_mfma_f32_32x32x16_bf16 v[128:143], v[216:219], v[36:39], v[128:143]
  v_mfma_f32_32x32x16_bf16 v[144:159], v[220:223], v[36:39], v[144:159]
  v_mfma_f32_32x32x16_bf16 v[128:143], v[224:227], v[40:43], v[128:143]
  v_mfma_f32_32x32x16_bf16 v[144:159], v[228:231], v[40:43], v[144:159]
  v_mfma_f32_32x32x16_bf16 v[128:143], v[232:235], v[44:47], v[128:143]
  v_mfma_f32_32x32x16_bf16 v[144:159], v[236:239], v[44:47], v[144:159]
  s_bitset0_b32 s42, 1
SK_kz_ker_16:
  s_bitcmp1_b32 s42, 2
  s_cbranch_scc0 SK_kz_ker_18
  s_waitcnt vmcnt(7)
  v_max3_u32 v3, v48, v49, v50
  s_waitcnt vmcnt(6)
  v_max3_u32 v4, v51, v52, v53
  v_max3_u32 v3, v3, v54, v55
  s_waitcnt vmcnt(5)
  v_max3_u32 v4, v4, v56, v57
  v_max3_u32 v3, v3, v58, v59
  s_waitcnt vmcnt(4)
  v_max3_u32 v4, v4, v60, v61
  v_max3_u32 v3, v3, v62, v63
  v_max_u32 v3, v3, v4
  v_cmp_lt_u32 vcc, s41, v3
  s_nop 4
  s_cbranch_vccnz FL_kz_ker_19
  v_mfma_f32_32x32x16_bf16 v[128:143], v[240:243], v[48:51], v[128:143]
  v_mfma_f32_32x32x16_bf16 v[144:159], v[244:247], v[48:51], v[144:159]
  v_mfma_f32_32x32x16_bf16 v[128:143], v[248:251], v[52:55], v[128:143]
  v_mfma_f32_32x32x16_bf16 v[144:159], v[252:255], v[52:55], v[144:159]
  v_mfma_f32_32x32x16_bf16 v[128:143], v[80:83], v[56:59], v[128:143]
  v_mfma_f32_32x32x16_bf16 v[144:159], v[84:87], v[56:59], v[144:159]
  v_mfma_f32_32x32x16_bf16 v[128:143], v[88:91], v[60:63], v[128:143]
  v_mfma_f32_32x32x16_bf16 v[144:159], v[92:95], v[60:63], v[144:159]
  s_bitset0_b32 s42, 2
SK_kz_ker_18:
  s_bitcmp1_b32 s42, 3
  s_cbranch_scc0 SK_kz_ker_20
  s_waitcnt vmcnt(3)
  v_max3_u32 v3, v64, v65, v66
  s_waitcnt vmcnt(2)
  v_max3_u32 v4, v67, v68, v69
  v_max3_u32 v3, v3, v70, v71
  s_waitcnt vmcnt(1)
  v_max3_u32 v4, v4, v72, v73
  v_max3_u32 v3, v3, v74, v75
  s_waitcnt vmcnt(0)
  v_max3_u32 v4, v4, v76, v77
  v_max3_u32 v3, v3, v78, v79
  v_max_u32 v3, v3, v4
  v_cmp_lt_u32 vcc, s41, v3
  s_nop 4
  s_cbranch_vccnz FL_kz_ker_21
  v_mfma_f32_32x32x16_bf16 v[128:143], v[96:99], v[64:67], v[128:143]
  v_mfma_f32_32x32x16_bf16 v[144:159], v[100:103], v[64:67], v[144:159]
  v_mfma_f32_32x32x16_bf16 v[128:143], v[104:107], v[68:71], v[128:143]
  v_mfma_f32_32x32x16_bf16 v[144:159], v[108:111], v[68:71], v[144:159]
  v_mfma_f32_32x32x16_bf16 v[128:143], v[112:115], v[72:75], v[128:143]
  v_mfma_f32_32x32x16_bf16 v[144:159], v[116:119], v[72:75], v[144:159]
  v_mfma_f32_32x32x16_bf16 v[128:143], v[120:123], v[76:79], v[128:143]
  v_mfma_f32_32x32x16_bf16 v[144:159], v[124:127], v[76:79], v[144:159]
  s_bitset0_b32 s42, 3
SK_kz_ker_20:
  s_cmp_eq_u32 s42, 0
  s_cbranch_scc1 P3D_kz_ker_13
  s_waitcnt vmcnt(0)
  s_sub_u32 s60, s60, 1
  s_cbranch_scc0 P3L_kz_ker_12
  s_mov_b32 s60, 0
  s_mov_b32 s41, -1
  s_branch P3L_kz_ker_12
P3D_kz_ker_13:
  s_waitcnt vmcnt(3)
  v_lshlrev_b32 v16, 16, v160
  v_and_b32 v17, 0xffff0000, v160
  v_lshlrev_b32 v18, 16, v161
  v_and_b32 v19, 0xffff0000, v161
  s_waitcnt vmcnt(2)
  v_lshlrev_b32 v20, 16, v162
  v_and_b32 v21, 0xffff0000, v162
  v_lshlrev_b32 v22, 16, v163
  v_and_b32 v23, 0xffff0000, v163
  s_waitcnt vmcnt(1)
  v_lshlrev_b32 v24, 16, v164
  v_and_b32 v25, 0xffff0000, v164
  v_lshlrev_b32 v26, 16, v165
  v_and_b32 v27, 0xffff0000, v165
  s_waitcnt vmcnt(0)
  v_lshlrev_b32 v28, 16, v166
  v_and_b32 v29, 0xffff0000, v166
  v_lshlrev_b32 v30, 16, v167
  v_and_b32 v31, 0xffff0000, v167
  ds_write_b128 v10, v[144:147] offset:0
  ds_write_b128 v10, v[148:151] offset:1024
  ds_write_b128 v10, v[152:155] offset:2048
  ds_write_b128 v10, v[156:159] offset:3072
  s_mov_b32 s26, 0x3f803f80
  v_mov_b32 v176, 0
  v_mov_b32 v177, 0
  v_mov_b32 v178, 0
  v_mov_b32 v179, 0
  v_pk_add_f32 v[128:129], v[128:129], v[16:17]
  v_pk_add_f32 v[130:131], v[130:131], v[18:19]
  v_pk_add_f32 v[132:133], v[132:133], v[20:21]
  v_pk_add_f32 v[134:135], v[134:135], v[22:23]
  v_pk_add_f32 v[136:137], v[136:137], v[24:25]
  v_pk_add_f32 v[138:139], v[138:139], v[26:27]
  v_pk_add_f32 v[140:141], v[140:141], v[28:29]
  v_pk_add_f32 v[142:143], v[142:143], v[30:31]
  s_waitcnt lgkmcnt(0)
  s_barrier
  ds_read_b128 v[144:147], v11 offset:0
  ds_read_b128 v[148:151], v11 offset:1024
  ds_read_b128 v[152:155], v11 offset:2048
  ds_read_b128 v[156:159], v11 offset:3072
  v_add_u32 v3, 157696, v8
  ds_read_b128 v[32:35], v3 offset:0
  ds_read_b128 v[36:39], v3 offset:512
  ds_read_b128 v[40:43], v3 offset:1024
  ds_read_b128 v[44:47], v3 offset:1536
  s_waitcnt lgkmcnt(7)
  v_pk_add_f32 v[128:129], v[128:129], v[144:145]
  v_pk_add_f32 v[130:131], v[130:131], v[146:147]
  s_waitcnt lgkmcnt(6)
  v_pk_add_f32 v[132:133], v[132:133], v[148:149]
  v_pk_add_f32 v[134:135], v[134:135], v[150:151]
  s_waitcnt lgkmcnt(5)
  v_pk_add_f32 v[136:137], v[136:137], v[152:153]
  v_pk_add_f32 v[138:139], v[138:139], v[154:155]
  s_waitcnt lgkmcnt(4)
  v_pk_add_f32 v[140:141], v[140:141], v[156:157]
  v_pk_add_f32 v[142:143], v[142:143], v[158:159]
  v_cvt_pk_bf16_f32 v168, v128, v129
  v_cvt_pk_bf16_f32 v169, v130, v131
  v_cvt_pk_bf16_f32 v170, v132, v133
  v_cvt_pk_bf16_f32 v171, v134, v135
  v_cvt_pk_bf16_f32 v172, v136, v137
  v_cvt_pk_bf16_f32 v173, v138, v139
  v_cvt_pk_bf16_f32 v174, v140, v141
  v_cvt_pk_bf16_f32 v175, v142, v143
  s_cmp_lg_u32 s61, 0
  s_cbranch_scc0 DS_kz_ker_22
  buffer_store_dwordx4 v[168:171], v2, s[8:11], s43 offen
DB_kz_ker_23:
  s_cmp_lg_u32 s61, 0
  s_cbranch_scc0 DS_kz_ker_24
  buffer_store_dwordx4 v[172:175], v2, s[8:11], s43 offen offset:1024
DB_kz_ker_25:
  v_dot2c_f32_bf16 v176, s26, v168
  v_dot2c_f32_bf16 v177, v168, v168
  v_dot2c_f32_bf16 v178, s26, v169
  v_dot2c_f32_bf16 v179, v169, v169
  v_dot2c_f32_bf16 v176, s26, v170
  v_dot2c_f32_bf16 v177, v170, v170
  v_dot2c_f32_bf16 v178, s26, v171
  v_dot2c_f32_bf16 v179, v171, v171
  v_dot2c_f32_bf16 v176, s26, v172
  v_dot2c_f32_bf16 v177, v172, v172
  v_dot2c_f32_bf16 v178, s26, v173
  v_dot2c_f32_bf16 v179, v173, v173
  v_dot2c_f32_bf16 v176, s26, v174
  v_dot2c_f32_bf16 v177, v174, v174
  v_dot2c_f32_bf16 v178, s26, v175
  v_dot2c_f32_bf16 v179, v175, v175
  s_nop 1
  v_add_f32 v176, v176, v178
  v_add_f32 v177, v177, v179
  v_mov_b32 v178, v176
  v_mov_b32 v179, v177
  s_nop 0
  v_permlane32_swap_b32 v178, v176
  v_permlane32_swap_b32 v179, v177
  v_add_f32 v176, v176, v178
  v_add_f32 v177, v177, v179
  s_cmp_lg_u32 s61, 0
  s_cbranch_scc0 DS_kz_ker_26
  buffer_store_dwordx2 v[176:177], v8, s[8:11], s44 offen
DB_kz_ker_27:
  s_waitcnt lgkmcnt(0)
  s_barrier
  v_add_f32 v32, v32, v33
  v_add_f32 v34, v34, v35
  v_add_f32 v16, v32, v34
  v_cvt_pk_bf16_f32 v3, v16, v16
  v_and_b32 v3, 0xffff0000, v3
  v_sub_f32 v4, v16, v3
  v_cvt_pk_bf16_f32 v16, v3, v4
  v_add_f32 v36, v36, v37
  v_add_f32 v38, v38, v39
  v_add_f32 v17, v36, v38
  v_cvt_pk_bf16_f32 v3, v17, v17
  v_and_b32 v3, 0xffff0000, v3
  v_sub_f32 v4, v17, v3
  v_cvt_pk_bf16_f32 v17, v3, v4
  v_add_f32 v40, v40, v41
  v_add_f32 v42, v42, v43
  v_add_f32 v18, v40, v42
  v_cvt_pk_bf16_f32 v3, v18, v18
  v_and_b32 v3, 0xffff0000, v3
  v_sub_f32 v4, v18, v3
  v_cvt_pk_bf16_f32 v18, v3, v4
  v_add_f32 v44, v44, v45
  v_add_f32 v46, v46, v47
  v_add_f32 v19, v44, v46
  v_cvt_pk_bf16_f32 v3, v19, v19
  v_and_b32 v3, 0xffff0000, v3
  v_sub_f32 v4, v19, v3
  v_cvt_pk_bf16_f32 v19, v3, v4
  v_mov_b32 v20, 0
  v_mov_b32 v21, 0
  v_mov_b32 v22, 0
  v_mov_b32 v23, 0
  v_mov_b32 v24, 0
  v_mov_b32 v25, 0
  v_mov_b32 v26, 0
  v_mov_b32 v27, 0
  v_mov_b32 v28, 0
  v_mov_b32 v29, 0
  v_cndmask_b32 v156, v2, v13, s[20:21]
  v_cndmask_b32 v157, v13, v12, s[20:21]
  v_cndmask_b32 v158, v12, v14, s[20:21]
  v_lshlrev_b32 v5, 1, v2
  s_mov_b32 s52, -1
  s_mov_b32 s53, 0
  s_waitcnt vmcnt(0)
  s_cmp_lg_u32 s61, 0
  s_cbranch_scc0 DS_kz_ker_28
  buffer_store_dwordx2 v[0:1], off, s[8:11], s45
DB_kz_ker_29:
  s_setprio 3
PL_kz_ker_30:
  buffer_load_dwordx2 v[10:11], v6, s[8:11], s46 offen sc1
  s_waitcnt vmcnt(0)
  v_cmp_eq_u64 vcc, s[56:57], v[10:11]
  s_andn2_b64 s[62:63], -1, vcc
  s_cmp_eq_u64 s[62:63], 0
  s_cbranch_scc1 PD_kz_ker_31
  s_sub_u32 s60, s60, 1
  s_cbranch_scc0 PL_kz_ker_30
  s_mov_b32 s60, 0
PD_kz_ker_31:
  buffer_load_dwordx4 v[160:163], v2, s[8:11], s47 offen offset:0 sc1
  buffer_load_dwordx4 v[164:167], v2, s[8:11], s47 offen offset:1024 sc1
  buffer_load_dwordx4 v[168:171], v2, s[8:11], s47 offen offset:2048 sc1
  buffer_load_dwordx4 v[172:175], v2, s[8:11], s47 offen offset:3072 sc1
  s_add_u32 s47, s47, 0x1000
  buffer_load_dwordx4 v[176:179], v2, s[8:11], s47 offen offset:0 sc1
  buffer_load_dwordx4 v[180:183], v2, s[8:11], s47 offen offset:1024 sc1
  buffer_load_dwordx4 v[184:187], v2, s[8:11], s47 offen offset:2048 sc1
  ds_read_b128 v[128:131], v2 offset:0
  ds_read_b128 v[132:135], v2 offset:1024
  ds_read_b128 v[136:139], v12 offset:0
  ds_read_b128 v[140:143], v12 offset:1024
  ds_read_b128 v[144:147], v2 offset:2048
  ds_read_b128 v[148:151], v2 offset:3072
  ds_read_b128 v[152:155], v12 offset:2048
  s_waitcnt vmcnt(6) lgkmcnt(6)
  v_mfma_f32_32x32x16_bf16 v[32:47], v[128:131], v[160:163], 0
  ds_read_b128 v[128:131], v12 offset:3072
  s_waitcnt lgkmcnt(6)
  v_mfma_f32_32x32x16_bf16 v[48:63], v[132:135], v[160:163], 0
  ds_read_b128 v[132:135], v2 offset:4096
  buffer_load_dwordx4 v[240:243], v9, s[8:11], s22 offen offset:0 sc1
  buffer_load_dwordx4 v[244:247], v9, s[8:11], s22 offen offset:512 sc1
  buffer_load_dwordx4 v[248:251], v9, s[8:11], s22 offen offset:1024 sc1
  buffer_load_dwordx4 v[252:255], v9, s[8:11], s22 offen offset:1536 sc1
  s_waitcnt lgkmcnt(6)
  v_mfma_f32_32x32x16_bf16 v[64:79], v[136:139], v[160:163], 0
  buffer_load_dwordx4 v[188:191], v2, s[8:11], s47 offen offset:3072 sc1
  ds_read_b128 v[136:139], v2 offset:5120
  s_waitcnt lgkmcnt(6)
  v_mfma_f32_32x32x16_bf16 v[80:95], v[140:143], v[160:163], 0
  ds_read_b128 v[140:143], v12 offset:4096
  s_waitcnt vmcnt(10) lgkmcnt(6)
  v_mfma_f32_32x32x16_bf16 v[32:47], v[144:147], v[164:167], v[32:47]
  ds_read_b128 v[144:147], v12 offset:5120
  s_waitcnt lgkmcnt(6)
  v_mfma_f32_32x32x16_bf16 v[48:63], v[148:151], v[164:167], v[48:63]
  s_add_u32 s47, s47, 0x1000
  buffer_load_dwordx4 v[192:195], v2, s[8:11], s47 offen offset:0 sc1
  ds_read_b128 v[148:151], v2 offset:6144
  s_waitcnt lgkmcnt(6)
  v_mfma_f32_32x32x16_bf16 v[64:79], v[152:155], v[164:167], v[64:79]
  ds_read_b128 v[152:155], v2 offset:7168
  s_waitcnt lgkmcnt(6)
  v_mfma_f32_32x32x16_bf16 v[80:95], v[128:131], v[164:167], v[80:95]
  ds_read_b128 v[128:131], v12 offset:6144
  s_waitcnt vmcnt(10) lgkmcnt(6)
  v_mfma_f32_32x32x16_bf16 v[32:47], v[132:135], v[168:171], v[32:47]
  buffer_load_dwordx4 v[196:199], v2, s[8:11], s47 offen offset:1024 sc1
  ds_read_b128 v[132:135], v12 offset:7168
  s_waitcnt lgkmcnt(6)
  v_mfma_f32_32x32x16_bf16 v[48:63], v[136:139], v[168:171], v[48:63]
  ds_read_b128 v[136:139], v2 offset:8192
  s_waitcnt lgkmcnt(6)
  v_mfma_f32_32x32x16_bf16 v[64:79], v[140:143], v[168:171], v[64:79]
  ds_read_b128 v[140:143], v2 offset:9216
  s_waitcnt lgkmcnt(6)
  v_mfma_f32_32x32x16_bf16 v[80:95], v[144:147], v[168:171], v[80:95]
  buffer_load_dwordx4 v[200:203], v2, s[8:11], s47 offen offset:2048 sc1
  ds_read_b128 v[144:147], v12 offset:8192
  s_waitcnt vmcnt(11) lgkmcnt(6)
  v_mfma_f32_32x32x16_bf16 v[32:47], v[148:151], v[172:175], v[32:47]
  ds_read_b128 v[148:151], v12 offset:9216
  s_waitcnt lgkmcnt(6)
  v_mfma_f32_32x32x16_bf16 v[48:63], v[152:155], v[172:175], v[48:63]
  ds_read_b128 v[152:155], v2 offset:10240
  s_waitcnt lgkmcnt(6)
  v_mfma_f32_32x32x16_bf16 v[64:79], v[128:131], v[172:175], v[64:79]
  buffer_load_dwordx4 v[204:207], v2, s[8:11], s47 offen offset:3072 sc1
  ds_read_b128 v[128:131], v2 offset:11264
  s_waitcnt lgkmcnt(6)
  v_mfma_f32_32x32x16_bf16 v[80:95], v[132:135], v[172:175], v[80:95]
  ds_read_b128 v[132:135], v12 offset:10240
  s_waitcnt vmcnt(11) lgkmcnt(6)
  v_mfma_f32_32x32x16_bf16 v[32:47], v[136:139], v[176:179], v[32:47]
  ds_read_b128 v[136:139], v12 offset:11264
  s_waitcnt lgkmcnt(6)
  v_mfma_f32_32x32x16_bf16 v[48:63], v[140:143], v[176:179], v[48:63]
  s_add_u32 s47, s47, 0x1000
  buffer_load_dwordx4 v[208:211], v2, s[8:11], s47 offen offset:0 sc1
  ds_read_b128 v[140:143], v2 offset:12288
  s_waitcnt lgkmcnt(6)
  v_mfma_f32_32x32x16_bf16 v[64:79], v[144:147], v[176:179], v[64:79]
  ds_read_b128 v[144:147], v2 offset:13312
  s_waitcnt lgkmcnt(6)
  v_mfma_f32_32x32x16_bf16 v[80:95], v[148:151], v[176:179], v[80:95]
  ds_read_b128 v[148:151], v12 offset:12288
  s_waitcnt vmcnt(11) lgkmcnt(6)
  v_mfma_f32_32x32x16_bf16 v[32:47], v[152:155], v[180:183], v[32:47]
  buffer_load_dwordx4 v[212:215], v2, s[8:11], s47 offen offset:1024 sc1
  ds_read_b128 v[152:155], v12 offset:13312
  s_waitcnt lgkmcnt(6)
  v_mfma_f32_32x32x16_bf16 v[48:63], v[128:131], v[180:183], v[48:63]
  ds_read_b128 v[128:131], v2 offset:14336
  s_waitcnt lgkmcnt(6)
  v_mfma_f32_32x32x16_bf16 v[64:79], v[132:135], v[180:183], v[64:79]
  ds_read_b128 v[132:135], v2 offset:15360
  s_waitcnt lgkmcnt(6)
  v_mfma_f32_32x32x16_bf16 v[80:95], v[136:139], v[180:183], v[80:95]
  buffer_load_dwordx4 v[216:219], v2, s[8:11], s47 offen offset:2048 sc1
  ds_read_b128 v[136:139], v12 offset:14336
  s_waitcnt vmcnt(12) lgkmcnt(6)
  v_mfma_f32_32x32x16_bf16 v[32:47], v[140:143], v[184:187], v[32:47]
  ds_read_b128 v[140:143], v12 offset:15360
  s_waitcnt lgkmcnt(6)
  v_mfma_f32_32x32x16_bf16 v[48:63], v[144:147], v[184:187], v[48:63]
  ds_read_b128 v[144:147], v2 offset:16384
  s_waitcnt lgkmcnt(6)
  v_mfma_f32_32x32x16_bf16 v[64:79], v[148:151], v[184:187], v[64:79]
  buffer_load_dwordx4 v[220:223], v2, s[8:11], s47 offen offset:3072 sc1
  ds_read_b128 v[148:151], v2 offset:17408
  s_waitcnt lgkmcnt(6)
  v_mfma_f32_32x32x16_bf16 v[80:95], v[152:155], v[184:187], v[80:95]
  ds_read_b128 v[152:155], v12 offset:16384
  s_waitcnt vmcnt(8) lgkmcnt(6)
  v_mfma_f32_32x32x16_bf16 v[32:47], v[128:131], v[188:191], v[32:47]
  ds_read_b128 v[128:131], v12 offset:17408
  s_waitcnt lgkmcnt(6)
  v_mfma_f32_32x32x16_bf16 v[48:63], v[132:135], v[188:191], v[48:63]
  s_add_u32 s47, s47, 0x1000
  buffer_load_dwordx4 v[224:227], v2, s[8:11], s47 offen offset:0 sc1
  ds_read_b128 v[132:135], v2 offset:18432
  s_waitcnt lgkmcnt(6)
  v_mfma_f32_32x32x16_bf16 v[64:79], v[136:139], v[188:191], v[64:79]
  v_add_f32 v240, v240, v242
  v_add_f32 v241, v241, v243
  v_add_f32 v244, v244, v246
  v_add_f32 v245, v245, v247
  ds_read_b128 v[136:139], v2 offset:19456
  s_waitcnt lgkmcnt(6)
  v_mfma_f32_32x32x16_bf16 v[80:95], v[140:143], v[188:191], v[80:95]
  v_add_f32 v248, v248, v250
  v_add_f32 v249, v249, v251
  v_add_f32 v252, v252, v254
  v_add_f32 v253, v253, v255
  ds_read_b128 v[140:143], v12 offset:18432
  s_waitcnt vmcnt(8) lgkmcnt(6)
  v_mfma_f32_32x32x16_bf16 v[32:47], v[144:147], v[192:195], v[32:47]
  v_add_f32 v240, v240, v244
  v_add_f32 v241, v241, v245
  v_add_f32 v248, v248, v252
  v_add_f32 v249, v249, v253
  buffer_load_dwordx4 v[228:231], v2, s[8:11], s47 offen offset:1024 sc1
  ds_read_b128 v[144:147], v12 offset:19456
  s_waitcnt lgkmcnt(6)
  v_mfma_f32_32x32x16_bf16 v[48:63], v[148:151], v[192:195], v[48:63]
  v_add_f32 v240, v240, v248
  v_add_f32 v241, v241, v249
  v_mov_b32 v242, v240
  ds_read_b128 v[148:151], v2 offset:20480
  s_waitcnt lgkmcnt(6)
  v_mfma_f32_32x32x16_bf16 v[64:79], v[152:155], v[192:195], v[64:79]
  v_mov_b32 v243, v241
  v_permlane32_swap_b32 v242, v240
  ds_read_b128 v[152:155], v2 offset:21504
  s_waitcnt lgkmcnt(6)
  v_mfma_f32_32x32x16_bf16 v[80:95], v[128:131], v[192:195], v[80:95]
  v_permlane32_swap_b32 v243, v241
  v_add_f32 v240, v240, v242
  buffer_load_dwordx4 v[232:235], v2, s[8:11], s47 offen offset:2048 sc1
  ds_read_b128 v[128:131], v12 offset:20480
  s_waitcnt vmcnt(9) lgkmcnt(6)
  v_mfma_f32_32x32x16_bf16 v[32:47], v[132:135], v[196:199], v[32:47]
  v_add_f32 v241, v241, v243
  v_mul_f32 v240, 0xbb000000, v240
  ds_read_b128 v[132:135], v12 offset:21504
  s_waitcnt lgkmcnt(6)
  v_mfma_f32_32x32x16_bf16 v[48:63], v[136:139], v[196:199], v[48:63]
  v_mul_f32 v241, 0x3b000000, v241
  v_cvt_pk_bf16_f32 v242, v240, v240
  ds_read_b128 v[136:139], v2 offset:22528
  s_waitcnt lgkmcnt(6)
  v_mfma_f32_32x32x16_bf16 v[64:79], v[140:143], v[196:199], v[64:79]
  v_fma_f32 v241, -v240, v240, v241
  v_cndmask_b32 v22, 0, v242, s[52:53]
  buffer_load_dwordx4 v[236:239], v2, s[8:11], s47 offen offset:3072 sc1
  ds_read_b128 v[140:143], v2 offset:23552
  s_waitcnt lgkmcnt(6)
  v_mfma_f32_32x32x16_bf16 v[80:95], v[144:147], v[196:199], v[80:95]
  v_max_f32 v241, 0, v241
  v_cvt_pk_bf16_f32 v241, v241, v241
  ds_read_b128 v[144:147], v12 offset:22528
  s_waitcnt vmcnt(9) lgkmcnt(6)
  v_mfma_f32_32x32x16_bf16 v[32:47], v[148:151], v[200:203], v[32:47]
  v_and_b32 v241, 0xffff0000, v241
  v_add_f32 v241, 0x3727c5ac, v241
  ds_read_b128 v[148:151], v12 offset:23552
  s_waitcnt lgkmcnt(6)
  v_mfma_f32_32x32x16_bf16 v[48:63], v[152:155], v[200:203], v[48:63]
  v_cvt_pk_bf16_f32 v241, v241, v241
  v_and_b32 v241, 0xffff0000, v241
  s_add_u32 s47, s47, 0x1000
  buffer_load_dwordx4 v[160:163], v2, s[8:11], s47 offen offset:0 sc1
  ds_read_b128 v[152:155], v2 offset:24576
  s_waitcnt lgkmcnt(6)
  v_mfma_f32_32x32x16_bf16 v[64:79], v[128:131], v[200:203], v[64:79]
  v_sqrt_f32 v241, v241
  s_nop 0
  v_cvt_pk_bf16_f32 v241, v241, v241
  ds_read_b128 v[128:131], v2 offset:25600
  s_waitcnt lgkmcnt(6)
  v_mfma_f32_32x32x16_bf16 v[80:95], v[132:135], v[200:203], v[80:95]
  v_and_b32 v241, 0xffff0000, v241
  v_rcp_f32 v10, v241
  ds_read_b128 v[132:135], v12 offset:24576
  s_waitcnt vmcnt(9) lgkmcnt(6)
  v_mfma_f32_32x32x16_bf16 v[32:47], v[136:139], v[204:207], v[32:47]
  v_mul_f32 v11, v241, v241
  v_mul_f32 v10, 0xbfb8aa3b, v10
  buffer_load_dwordx4 v[164:167], v2, s[8:11], s47 offen offset:1024 sc1
  ds_read_b128 v[136:139], v12 offset:25600
  s_waitcnt lgkmcnt(6)
  v_mfma_f32_32x32x16_bf16 v[48:63], v[140:143], v[204:207], v[48:63]
  v_mov_b32 v27, v22
  ds_read_b128 v[140:143], v2 offset:26624
  s_waitcnt lgkmcnt(6)
  v_mfma_f32_32x32x16_bf16 v[64:79], v[144:147], v[204:207], v[64:79]
  ds_read_b128 v[144:147], v2 offset:27648
  s_waitcnt lgkmcnt(6)
  v_mfma_f32_32x32x16_bf16 v[80:95], v[148:151], v[204:207], v[80:95]
  buffer_load_dwordx4 v[168:171], v2, s[8:11], s47 offen offset:2048 sc1
  ds_read_b128 v[148:151], v12 offset:26624
  s_waitcnt vmcnt(10) lgkmcnt(6)
  v_mfma_f32_32x32x16_bf16 v[32:47], v[152:155], v[208:211], v[32:47]
  ds_read_b128 v[152:155], v12 offset:27648
  s_waitcnt lgkmcnt(6)
  v_mfma_f32_32x32x16_bf16 v[48:63], v[128:131], v[208:211], v[48:63]
  ds_read_b128 v[128:131], v2 offset:28672
  s_waitcnt lgkmcnt(6)
  v_mfma_f32_32x32x16_bf16 v[64:79], v[132:135], v[208:211], v[64:79]
  buffer_load_dwordx4 v[172:175], v2, s[8:11], s47 offen offset:3072 sc1
  ds_read_b128 v[132:135], v2 offset:29696
  s_waitcnt lgkmcnt(6)
  v_mfma_f32_32x32x16_bf16 v[80:95], v[136:139], v[208:211], v[80:95]
  ds_read_b128 v[136:139], v12 offset:28672
  s_waitcnt vmcnt(10) lgkmcnt(6)
  v_mfma_f32_32x32x16_bf16 v[32:47], v[140:143], v[212:215], v[32:47]
  ds_read_b128 v[140:143], v12 offset:29696
  s_waitcnt lgkmcnt(6)
  v_mfma_f32_32x32x16_bf16 v[48:63], v[144:147], v[212:215], v[48:63]
  s_add_u32 s47, s47, 0x1000
  buffer_load_dwordx4 v[176:179], v2, s[8:11], s47 offen offset:0 sc1
  ds_read_b128 v[144:147], v2 offset:30720
  s_waitcnt lgkmcnt(6)
  v_mfma_f32_32x32x16_bf16 v[64:79], v[148:151], v[212:215], v[64:79]
  ds_read_b128 v[148:151], v2 offset:31744
  s_waitcnt lgkmcnt(6)
  v_mfma_f32_32x32x16_bf16 v[80:95], v[152:155], v[212:215], v[80:95]
  ds_read_b128 v[152:155], v12 offset:30720
  s_xor_b32 s22, s22, 0x4000
  buffer_load_dwordx4 v[180:183], v9, s[8:11], s22 offen offset:0 sc1
  buffer_load_dwordx4 v[184:187], v9, s[8:11], s22 offen offset:512 sc1
  buffer_load_dwordx4 v[188:191], v9, s[8:11], s22 offen offset:1024 sc1
  buffer_load_dwordx4 v[192:195], v9, s[8:11], s22 offen offset:1536 sc1
  s_waitcnt vmcnt(14) lgkmcnt(6)
  v_mfma_f32_32x32x16_bf16 v[32:47], v[128:131], v[216:219], v[32:47]
  buffer_load_dwordx4 v[196:199], v2, s[8:11], s47 offen offset:1024 sc1
  ds_read_b128 v[128:131], v12 offset:31744
  s_waitcnt lgkmcnt(6)
  v_mfma_f32_32x32x16_bf16 v[48:63], v[132:135], v[216:219], v[48:63]
  ds_read_b128 v[132:135], v2 offset:32768
  s_waitcnt lgkmcnt(6)
  v_mfma_f32_32x32x16_bf16 v[64:79], v[136:139], v[216:219], v[64:79]
  ds_read_b128 v[136:139], v2 offset:33792
  s_waitcnt lgkmcnt(6)
  v_mfma_f32_32x32x16_bf16 v[80:95], v[140:143], v[216:219], v[80:95]
  buffer_load_dwordx4 v[200:203], v2, s[8:11], s47 offen offset:2048 sc1
  ds_read_b128 v[140:143], v12 offset:32768
  s_waitcnt vmcnt(15) lgkmcnt(6)
  v_mfma_f32_32x32x16_bf16 v[32:47], v[144:147], v[220:223], v[32:47]
  ds_read_b128 v[144:147], v12 offset:33792
  s_waitcnt lgkmcnt(6)
  v_mfma_f32_32x32x16_bf16 v[48:63], v[148:151], v[220:223], v[48:63]
  ds_read_b128 v[148:151], v2 offset:34816
  s_waitcnt lgkmcnt(6)
  v_mfma_f32_32x32x16_bf16 v[64:79], v[152:155], v[220:223], v[64:79]
  buffer_load_dwordx4 v[240:243], v2, s[8:11], s47 offen offset:3072 sc1
  ds_read_b128 v[152:155], v2 offset:35840
  s_waitcnt lgkmcnt(6)
  v_mfma_f32_32x32x16_bf16 v[80:95], v[128:131], v[220:223], v[80:95]
  ds_read_b128 v[128:131], v12 offset:34816
  s_waitcnt vmcnt(15) lgkmcnt(6)
  v_mfma_f32_32x32x16_bf16 v[32:47], v[132:135], v[224:227], v[32:47]
  ds_read_b128 v[132:135], v12 offset:35840
  s_waitcnt lgkmcnt(6)
  v_mfma_f32_32x32x16_bf16 v[48:63], v[136:139], v[224:227], v[48:63]
  s_add_u32 s47, s47, 0x1000
  buffer_load_dwordx4 v[244:247], v2, s[8:11], s47 offen offset:0 sc1
  ds_read_b128 v[136:139], v2 offset:36864
  s_waitcnt lgkmcnt(6)
  v_mfma_f32_32x32x16_bf16 v[64:79], v[140:143], v[224:227], v[64:79]
  ds_read_b128 v[140:143], v2 offset:37888
  s_waitcnt lgkmcnt(6)
  v_mfma_f32_32x32x16_bf16 v[80:95], v[144:147], v[224:227], v[80:95]
  ds_read_b128 v[144:147], v12 offset:36864
  s_waitcnt vmcnt(15) lgkmcnt(6)
  v_mfma_f32_32x32x16_bf16 v[32:47], v[148:151], v[228:231], v[32:47]
  buffer_load_dwordx4 v[248:251], v2, s[8:11], s47 offen offset:1024 sc1
  ds_read_b128 v[148:151], v12 offset:37888
  s_waitcnt lgkmcnt(6)
  v_mfma_f32_32x32x16_bf16 v[48:63], v[152:155], v[228:231], v[48:63]
  ds_read_b128 v[152:155], v2 offset:38912
  s_waitcnt lgkmcnt(6)
  v_mfma_f32_32x32x16_bf16 v[64:79], v[128:131], v[228:231], v[64:79]
  ds_read_b128 v[128:131], v2 offset:39936
  s_waitcnt lgkmcnt(6)
  v_mfma_f32_32x32x16_bf16 v[80:95], v[132:135], v[228:231], v[80:95]
  buffer_load_dwordx4 v[252:255], v2, s[8:11], s47 offen offset:2048 sc1
  ds_read_b128 v[132:135], v12 offset:38912
  s_waitcnt vmcnt(16) lgkmcnt(6)
  v_mfma_f32_32x32x16_bf16 v[32:47], v[136:139], v[232:235], v[32:47]
  ds_read_b128 v[136:139], v12 offset:39936
  s_waitcnt lgkmcnt(6)
  v_mfma_f32_32x32x16_bf16 v[48:63], v[140:143], v[232:235], v[48:63]
  ds_read_b128 v[140:143], v2 offset:40960
  s_waitcnt lgkmcnt(6)
  v_mfma_f32_32x32x16_bf16 v[64:79], v[144:147], v[232:235], v[64:79]
  buffer_load_dwordx4 v[204:207], v2, s[8:11], s47 offen offset:3072 sc1
  ds_read_b128 v[144:147], v2 offset:41984
  s_waitcnt lgkmcnt(6)
  v_mfma_f32_32x32x16_bf16 v[80:95], v[148:151], v[232:235], v[80:95]
  ds_read_b128 v[148:151], v12 offset:40960
  s_waitcnt vmcnt(16) lgkmcnt(6)
  v_mfma_f32_32x32x16_bf16 v[32:47], v[152:155], v[236:239], v[32:47]
  s_waitcnt vmcnt(10)
  v_add_f32 v180, v180, v182
  v_add_f32 v181, v181, v183
  s_waitcnt vmcnt(9)
  v_add_f32 v184, v184, v186
  v_add_f32 v185, v185, v187
  ds_read_b128 v[152:155], v12 offset:41984
  s_waitcnt lgkmcnt(6)
  v_mfma_f32_32x32x16_bf16 v[48:63], v[128:131], v[236:239], v[48:63]
  s_waitcnt vmcnt(8)
  v_add_f32 v188, v188, v190
  v_add_f32 v189, v189, v191
  s_waitcnt vmcnt(7)
  v_add_f32 v192, v192, v194
  v_add_f32 v193, v193, v195
  buffer_load_dwordx4 v[208:211], v2, s[8:11], s31 offen offset:0 sc1
  ds_read_b128 v[128:131], v2 offset:43008
  s_waitcnt lgkmcnt(6)
  v_mfma_f32_32x32x16_bf16 v[64:79], v[132:135], v[236:239], v[64:79]
  v_add_f32 v180, v180, v184
  v_add_f32 v181, v181, v185
  v_add_f32 v188, v188, v192
  v_add_f32 v189, v189, v193
  ds_read_b128 v[132:135], v2 offset:44032
  s_waitcnt lgkmcnt(6)
  v_mfma_f32_32x32x16_bf16 v[80:95], v[136:139], v[236:239], v[80:95]
  v_add_f32 v180, v180, v188
  v_add_f32 v181, v181, v189
  v_mov_b32 v182, v180
  ds_read_b128 v[136:139], v12 offset:43008
  s_waitcnt lgkmcnt(6)
  v_mfma_f32_32x32x16_bf16 v[32:47], v[140:143], v[160:163], v[32:47]
  v_mov_b32 v183, v181
  v_permlane32_swap_b32 v182, v180
  buffer_load_dwordx4 v[212:215], v2, s[8:11], s31 offen offset:1024 sc1
  ds_read_b128 v[140:143], v12 offset:44032
  s_waitcnt lgkmcnt(6)
  v_mfma_f32_32x32x16_bf16 v[48:63], v[144:147], v[160:163], v[48:63]
  v_permlane32_swap_b32 v183, v181
  v_add_f32 v180, v180, v182
  ds_read_b128 v[144:147], v2 offset:45056
  s_waitcnt lgkmcnt(6)
  v_mfma_f32_32x32x16_bf16 v[64:79], v[148:151], v[160:163], v[64:79]
  v_add_f32 v181, v181, v183
  v_mul_f32 v180, 0xbb000000, v180
  ds_read_b128 v[148:151], v2 offset:46080
  s_waitcnt lgkmcnt(6)
  v_mfma_f32_32x32x16_bf16 v[80:95], v[152:155], v[160:163], v[80:95]
  v_mul_f32 v181, 0x3b000000, v181
  v_cvt_pk_bf16_f32 v182, v180, v180
  buffer_load_dwordx4 v[216:219], v2, s[8:11], s31 offen offset:2048 sc1
  ds_read_b128 v[152:155], v12 offset:45056
  s_waitcnt lgkmcnt(6)
  v_mfma_f32_32x32x16_bf16 v[32:47], v[128:131], v[164:167], v[32:47]
  v_fma_f32 v181, -v180, v180, v181
  v_cndmask_b32 v159, 0, v182, s[52:53]
  ds_read_b128 v[128:131], v12 offset:46080
  s_waitcnt lgkmcnt(6)
  v_mfma_f32_32x32x16_bf16 v[48:63], v[132:135], v[164:167], v[48:63]
  v_max_f32 v181, 0, v181
  v_cvt_pk_bf16_f32 v181, v181, v181
  ds_read_b128 v[132:135], v2 offset:47104
  s_waitcnt lgkmcnt(6)
  v_mfma_f32_32x32x16_bf16 v[64:79], v[136:139], v[164:167], v[64:79]
  v_and_b32 v181, 0xffff0000, v181
  v_add_f32 v181, 0x3727c5ac, v181
  buffer_load_dwordx4 v[220:223], v2, s[8:11], s31 offen offset:3072 sc1
  ds_read_b128 v[136:139], v2 offset:48128
  s_waitcnt lgkmcnt(6)
  v_mfma_f32_32x32x16_bf16 v[80:95], v[140:143], v[164:167], v[80:95]
  v_cvt_pk_bf16_f32 v181, v181, v181
  v_and_b32 v181, 0xffff0000, v181
  ds_read_b128 v[140:143], v12 offset:47104
  s_waitcnt lgkmcnt(6)
  v_mfma_f32_32x32x16_bf16 v[32:47], v[144:147], v[168:171], v[32:47]
  v_sqrt_f32 v181, v181
  s_nop 0
  v_cvt_pk_bf16_f32 v181, v181, v181
  ds_read_b128 v[144:147], v12 offset:48128
  s_waitcnt lgkmcnt(6)
  v_mfma_f32_32x32x16_bf16 v[48:63], v[148:151], v[168:171], v[48:63]
  v_and_b32 v181, 0xffff0000, v181
  v_rcp_f32 v30, v181
  s_add_u32 s31, s31, 0x1000
  buffer_load_dwordx4 v[224:227], v2, s[8:11], s31 offen offset:0 sc1
  ds_read_b128 v[148:151], v2 offset:49152
  s_waitcnt lgkmcnt(6)
  v_mfma_f32_32x32x16_bf16 v[64:79], v[152:155], v[168:171], v[64:79]
  v_mul_f32 v31, v181, v181
  v_mul_f32 v30, 0xbfb8aa3b, v30
  ds_read_b128 v[152:155], v2 offset:51200
  s_waitcnt lgkmcnt(6)
  v_mfma_f32_32x32x16_bf16 v[80:95], v[128:131], v[168:171], v[80:95]
  ds_read_b128 v[128:131], v2 offset:53248
  s_waitcnt lgkmcnt(6)
  v_mfma_f32_32x32x16_bf16 v[32:47], v[132:135], v[172:175], v[32:47]
  buffer_load_dwordx4 v[228:231], v2, s[8:11], s31 offen offset:1024 sc1
  ds_read_b128 v[132:135], v2 offset:55296
  s_waitcnt lgkmcnt(6)
  v_mfma_f32_32x32x16_bf16 v[48:63], v[136:139], v[172:175], v[48:63]
  ds_read_b128 v[136:139], v2 offset:57344
  s_waitcnt lgkmcnt(6)
  v_mfma_f32_32x32x16_bf16 v[64:79], v[140:143], v[172:175], v[64:79]
  ds_read_b128 v[140:143], v2 offset:59392
  s_waitcnt lgkmcnt(6)
  v_mfma_f32_32x32x16_bf16 v[80:95], v[144:147], v[172:175], v[80:95]
  buffer_load_dwordx4 v[232:235], v2, s[8:11], s31 offen offset:2048 sc1
  ds_read_b128 v[144:147], v2 offset:61440
  s_waitcnt lgkmcnt(6)
  v_mfma_f32_32x32x16_bf16 v[32:47], v[148:151], v[176:179], v[32:47]
  ds_read_b128 v[148:151], v2 offset:63488
  s_waitcnt vmcnt(13) lgkmcnt(6)
  v_mfma_f32_32x32x16_bf16 v[32:47], v[152:155], v[196:199], v[32:47]
  s_waitcnt vmcnt(12) lgkmcnt(5)
  v_mfma_f32_32x32x16_bf16 v[32:47], v[128:131], v[200:203], v[32:47]
  buffer_load_dwordx4 v[236:239], v2, s[8:11], s31 offen offset:3072 sc1
  ds_read_b128 v[152:155], v2 offset:50176
  s_waitcnt vmcnt(12) lgkmcnt(5)
  v_mfma_f32_32x32x16_bf16 v[32:47], v[132:135], v[240:243], v[32:47]
  ds_read_b128 v[128:131], v2 offset:52224
  s_waitcnt vmcnt(11) lgkmcnt(5)
  v_mfma_f32_32x32x16_bf16 v[32:47], v[136:139], v[244:247], v[32:47]
  ds_read_b128 v[132:135], v2 offset:54272
  s_waitcnt vmcnt(10) lgkmcnt(5)
  v_mfma_f32_32x32x16_bf16 v[32:47], v[140:143], v[248:251], v[32:47]
  s_add_u32 s31, s31, 0x1000
  buffer_load_dwordx4 v[160:163], v2, s[8:11], s31 offen offset:0 sc1
  ds_read_b128 v[136:139], v2 offset:56320
  s_waitcnt vmcnt(10) lgkmcnt(5)
  v_mfma_f32_32x32x16_bf16 v[32:47], v[144:147], v[252:255], v[32:47]
  ds_read_b128 v[140:143], v2 offset:58368
  s_waitcnt vmcnt(9) lgkmcnt(5)
  v_mfma_f32_32x32x16_bf16 v[32:47], v[148:151], v[204:207], v[32:47]
  ds_read_b128 v[144:147], v2 offset:60416
  v_mfma_f32_32x32x16_bf16 v[32:47], v[16:19], v[22:25], v[32:47]
  buffer_load_dwordx4 v[164:167], v2, s[8:11], s31 offen offset:1024 sc1
  ds_read_b128 v[148:151], v2 offset:62464
  s_waitcnt lgkmcnt(6)
  v_mfma_f32_32x32x16_bf16 v[48:63], v[152:155], v[176:179], v[48:63]
  ds_read_b128 v[152:155], v2 offset:64512
  s_waitcnt lgkmcnt(6)
  v_mfma_f32_32x32x16_bf16 v[48:63], v[128:131], v[196:199], v[48:63]
  s_nop 4
  v_mul_f32 v40, v32, v40
  v_mul_f32 v32, v32, v10
  v_mul_f32 v41, v33, v41
  v_mul_f32 v33, v33, v10
  s_waitcnt lgkmcnt(5)
  v_mfma_f32_32x32x16_bf16 v[48:63], v[132:135], v[200:203], v[48:63]
  v_exp_f32 v32, v32
  v_mul_f32 v42, v34, v42
  v_mul_f32 v34, v34, v10
  buffer_load_dwordx4 v[180:183], v2, s[8:11], s31 offen offset:2048 sc1
  ds_read_b128 v[128:131], v12 offset:49152
  s_waitcnt lgkmcnt(5)
  v_mfma_f32_32x32x16_bf16 v[48:63], v[136:139], v[240:243], v[48:63]
  v_exp_f32 v33, v33
  v_fma_f32 v32, v32, v11, v11
  v_mul_f32 v43, v35, v43
  ds_read_b128 v[132:135], v12 offset:51200
  s_waitcnt lgkmcnt(5)
  v_mfma_f32_32x32x16_bf16 v[48:63], v[140:143], v[244:247], v[48:63]
  v_mul_f32 v35, v35, v10
  v_exp_f32 v34, v34
  v_fma_f32 v33, v33, v11, v11
  ds_read_b128 v[136:139], v12 offset:53248
  s_waitcnt lgkmcnt(5)
  v_mfma_f32_32x32x16_bf16 v[48:63], v[144:147], v[248:251], v[48:63]
  v_rcp_f32 v32, v32
  v_mul_f32 v44, v36, v44
  v_mul_f32 v36, v36, v10
  buffer_load_dwordx4 v[184:187], v2, s[8:11], s31 offen offset:3072 sc1
  ds_read_b128 v[140:143], v12 offset:55296
  s_waitcnt lgkmcnt(5)
  v_mfma_f32_32x32x16_bf16 v[48:63], v[148:151], v[252:255], v[48:63]
  v_exp_f32 v35, v35
  v_fma_f32 v34, v34, v11, v11
  ds_read_b128 v[144:147], v12 offset:57344
  s_waitcnt lgkmcnt(5)
  v_mfma_f32_32x32x16_bf16 v[48:63], v[152:155], v[204:207], v[48:63]
  v_rcp_f32 v33, v33
  v_mul_f32 v40, v40, v32
  v_mul_f32 v45, v37, v45
  ds_read_b128 v[148:151], v12 offset:59392
  v_mfma_f32_32x32x16_bf16 v[48:63], v[16:19], v[26:29], v[48:63]
  v_mul_f32 v37, v37, v10
  v_exp_f32 v36, v36
  v_fma_f32 v35, v35, v11, v11
  s_add_u32 s31, s31, 0x1000
  buffer_load_dwordx4 v[188:191], v2, s[8:11], s31 offen offset:0 sc1
  ds_read_b128 v[152:155], v12 offset:61440
  s_waitcnt lgkmcnt(6)
  v_mfma_f32_32x32x16_bf16 v[64:79], v[128:131], v[176:179], v[64:79]
  v_rcp_f32 v34, v34
  v_mul_f32 v41, v41, v33
  v_mul_f32 v46, v38, v46
  ds_read_b128 v[128:131], v12 offset:63488
  s_waitcnt lgkmcnt(6)
  v_mfma_f32_32x32x16_bf16 v[64:79], v[132:135], v[196:199], v[64:79]
  v_mul_f32 v38, v38, v10
  v_exp_f32 v37, v37
  v_fma_f32 v36, v36, v11, v11
  s_waitcnt lgkmcnt(5)
  v_mfma_f32_32x32x16_bf16 v[64:79], v[136:139], v[200:203], v[64:79]
  v_rcp_f32 v35, v35
  v_mul_f32 v42, v42, v34
  v_cvt_pk_bf16_f32 v32, v40, v41
  buffer_load_dwordx4 v[192:195], v2, s[8:11], s31 offen offset:1024 sc1
  ds_read_b128 v[132:135], v12 offset:50176
  s_waitcnt lgkmcnt(5)
  v_mfma_f32_32x32x16_bf16 v[64:79], v[140:143], v[240:243], v[64:79]
  v_mul_f32 v47, v39, v47
  v_mul_f32 v39, v39, v10
  v_exp_f32 v38, v38
  ds_read_b128 v[136:139], v12 offset:52224
  s_waitcnt lgkmcnt(5)
  v_mfma_f32_32x32x16_bf16 v[64:79], v[144:147], v[244:247], v[64:79]
  v_fma_f32 v37, v37, v11, v11
  v_rcp_f32 v36, v36
  v_mul_f32 v43, v43, v35
  ds_read_b128 v[140:143], v12 offset:54272
  s_waitcnt lgkmcnt(5)
  v_mfma_f32_32x32x16_bf16 v[64:79], v[148:151], v[248:251], v[64:79]
  v_exp_f32 v39, v39
  v_fma_f32 v38, v38, v11, v11
  buffer_load_dwordx4 v[168:171], v2, s[8:11], s31 offen offset:2048 sc1
  ds_read_b128 v[144:147], v12 offset:56320
  s_waitcnt lgkmcnt(5)
  v_mfma_f32_32x32x16_bf16 v[64:79], v[152:155], v[252:255], v[64:79]
  v_rcp_f32 v37, v37
  v_mul_f32 v44, v44, v36
  v_cvt_pk_bf16_f32 v33, v42, v43
  ds_read_b128 v[148:151], v12 offset:58368
  s_waitcnt lgkmcnt(5)
  v_mfma_f32_32x32x16_bf16 v[64:79], v[128:131], v[204:207], v[64:79]
  v_fma_f32 v39, v39, v11, v11
  v_rcp_f32 v38, v38
  v_mul_f32 v45, v45, v37
  ds_read_b128 v[152:155], v12 offset:60416
  v_mfma_f32_32x32x16_bf16 v[64:79], v[16:19], v[20:23], v[64:79]
  v_rcp_f32 v39, v39
  v_mul_f32 v46, v46, v38
  v_cvt_pk_bf16_f32 v34, v44, v45
  buffer_load_dwordx4 v[172:175], v2, s[8:11], s31 offen offset:3072 sc1
  ds_read_b128 v[128:131], v12 offset:62464
  s_waitcnt lgkmcnt(6)
  v_mfma_f32_32x32x16_bf16 v[80:95], v[132:135], v[176:179], v[80:95]
  v_mul_f32 v47, v47, v39
  v_cvt_pk_bf16_f32 v35, v46, v47
  s_cmp_lg_u32 s61, 0
  s_cbranch_scc0 DS_kz_ker_32
  buffer_store_dwordx4 v[32:35], v2, s[8:11], s16 offen
DB_kz_ker_33:
  s_add_u32 s16, s16, 0x1000
  ds_read_b128 v[132:135], v12 offset:64512
  s_waitcnt lgkmcnt(6)
  v_mfma_f32_32x32x16_bf16 v[80:95], v[136:139], v[196:199], v[80:95]
  v_mul_f32 v56, v48, v56
  v_mul_f32 v48, v48, v10
  v_mul_f32 v57, v49, v57
  v_mul_f32 v49, v49, v10
  s_waitcnt lgkmcnt(5)
  v_mfma_f32_32x32x16_bf16 v[80:95], v[140:143], v[200:203], v[80:95]
  v_exp_f32 v48, v48
  v_mul_f32 v58, v50, v58
  v_mul_f32 v50, v50, v10
  s_add_u32 s31, s31, 0x1000
  buffer_load_dwordx4 v[176:179], v2, s[8:11], s31 offen offset:0 sc1
  ds_read_b128 v[136:139], v156 offset:0
  s_waitcnt lgkmcnt(5)
  v_mfma_f32_32x32x16_bf16 v[80:95], v[144:147], v[240:243], v[80:95]
  v_exp_f32 v49, v49
  v_fma_f32 v48, v48, v11, v11
  v_mul_f32 v59, v51, v59
  ds_read_b128 v[140:143], v157 offset:0
  s_waitcnt lgkmcnt(5)
  v_mfma_f32_32x32x16_bf16 v[80:95], v[148:151], v[244:247], v[80:95]
  v_mul_f32 v51, v51, v10
  v_exp_f32 v50, v50
  v_fma_f32 v49, v49, v11, v11
  ds_read_b128 v[144:147], v158 offset:0
  s_waitcnt lgkmcnt(5)
  v_mfma_f32_32x32x16_bf16 v[80:95], v[152:155], v[248:251], v[80:95]
  v_rcp_f32 v48, v48
  v_mul_f32 v60, v52, v60
  v_mul_f32 v52, v52, v10
  buffer_load_dwordx4 v[196:199], v2, s[8:11], s31 offen offset:1024 sc1
  ds_read_b128 v[148:151], v156 offset:2048
  s_waitcnt lgkmcnt(5)
  v_mfma_f32_32x32x16_bf16 v[80:95], v[128:131], v[252:255], v[80:95]
  v_exp_f32 v51, v51
  v_fma_f32 v50, v50, v11, v11
  ds_read_b128 v[152:155], v157 offset:2048
  s_waitcnt lgkmcnt(5)
  v_mfma_f32_32x32x16_bf16 v[80:95], v[132:135], v[204:207], v[80:95]
  v_rcp_f32 v49, v49
  v_mul_f32 v56, v56, v48
  v_mul_f32 v61, v53, v61
  ds_read_b128 v[128:131], v158 offset:2048
  v_mfma_f32_32x32x16_bf16 v[80:95], v[16:19], v[24:27], v[80:95]
  v_mul_f32 v53, v53, v10
  v_exp_f32 v52, v52
  v_fma_f32 v51, v51, v11, v11
  buffer_load_dwordx4 v[200:203], v2, s[8:11], s31 offen offset:2048 sc1
  ds_read_b128 v[132:135], v156 offset:4096
  s_waitcnt vmcnt(19) lgkmcnt(6)
  v_mfma_f32_32x32x16_bf16 v[96:111], v[136:139], v[208:211], 0
  v_rcp_f32 v50, v50
  v_mul_f32 v57, v57, v49
  v_mul_f32 v62, v54, v62
  ds_read_b128 v[136:139], v157 offset:4096
  s_waitcnt lgkmcnt(6)
  v_mfma_f32_32x32x16_bf16 v[112:127], v[140:143], v[208:211], 0
  v_mul_f32 v54, v54, v10
  v_exp_f32 v53, v53
  v_fma_f32 v52, v52, v11, v11
  ds_read_b128 v[140:143], v158 offset:4096
  v_cndmask_b32 v16, v16, v17, s[20:21]
  v_cndmask_b32 v17, v17, v18, s[20:21]
  v_cndmask_b32 v18, v18, v19, s[20:21]
  v_mov_b32 v22, v159
  v_mov_b32 v27, v159
  s_waitcnt lgkmcnt(6)
  v_mfma_f32_32x32x16_bf16 v[32:47], v[144:147], v[208:211], 0
  v_rcp_f32 v51, v51
  v_mul_f32 v58, v58, v50
  v_cvt_pk_bf16_f32 v48, v56, v57
  buffer_load_dwordx4 v[240:243], v2, s[8:11], s31 offen offset:3072 sc1
  ds_read_b128 v[144:147], v156 offset:6144
  s_waitcnt vmcnt(19) lgkmcnt(6)
  v_mfma_f32_32x32x16_bf16 v[96:111], v[148:151], v[212:215], v[96:111]
  v_mul_f32 v63, v55, v63
  v_mul_f32 v55, v55, v10
  v_exp_f32 v54, v54
  ds_read_b128 v[148:151], v157 offset:6144
  s_waitcnt lgkmcnt(6)
  v_mfma_f32_32x32x16_bf16 v[112:127], v[152:155], v[212:215], v[112:127]
  v_fma_f32 v53, v53, v11, v11
  v_rcp_f32 v52, v52
  v_mul_f32 v59, v59, v51
  ds_read_b128 v[152:155], v158 offset:6144
  s_waitcnt lgkmcnt(6)
  v_mfma_f32_32x32x16_bf16 v[32:47], v[128:131], v[212:215], v[32:47]
  v_exp_f32 v55, v55
  v_fma_f32 v54, v54, v11, v11
  s_add_u32 s31, s31, 0x1000
  buffer_load_dwordx4 v[244:247], v2, s[8:11], s31 offen offset:0 sc1
  ds_read_b128 v[128:131], v156 offset:8192
  s_waitcnt vmcnt(19) lgkmcnt(6)
  v_mfma_f32_32x32x16_bf16 v[96:111], v[132:135], v[216:219], v[96:111]
  v_rcp_f32 v53, v53
  v_mul_f32 v60, v60, v52
  v_cvt_pk_bf16_f32 v49, v58, v59
  ds_read_b128 v[132:135], v157 offset:8192
  s_waitcnt lgkmcnt(6)
  v_mfma_f32_32x32x16_bf16 v[112:127], v[136:139], v[216:219], v[112:127]
  v_fma_f32 v55, v55, v11, v11
  v_rcp_f32 v54, v54
  v_mul_f32 v61, v61, v53
  ds_read_b128 v[136:139], v158 offset:8192
  s_waitcnt lgkmcnt(6)
  v_mfma_f32_32x32x16_bf16 v[32:47], v[140:143], v[216:219], v[32:47]
  v_rcp_f32 v55, v55
  v_mul_f32 v62, v62, v54
  v_cvt_pk_bf16_f32 v50, v60, v61
  buffer_load_dwordx4 v[248:251], v2, s[8:11], s31 offen offset:1024 sc1
  ds_read_b128 v[140:143], v156 offset:10240
  s_waitcnt vmcnt(19) lgkmcnt(6)
  v_mfma_f32_32x32x16_bf16 v[96:111], v[144:147], v[220:223], v[96:111]
  v_mul_f32 v63, v63, v55
  v_cvt_pk_bf16_f32 v51, v62, v63
  s_cmp_lg_u32 s61, 0
  s_cbranch_scc0 DS_kz_ker_34
  buffer_store_dwordx4 v[48:51], v2, s[8:11], s16 offen
DB_kz_ker_35:
  s_add_u32 s16, s16, 0x1000
  ds_read_b128 v[144:147], v157 offset:10240
  s_waitcnt lgkmcnt(6)
  v_mfma_f32_32x32x16_bf16 v[112:127], v[148:151], v[220:223], v[112:127]
  v_mul_f32 v72, v64, v72
  v_mul_f32 v64, v64, v10
  v_mul_f32 v73, v65, v73
  v_mul_f32 v65, v65, v10
  ds_read_b128 v[148:151], v158 offset:10240
  s_waitcnt lgkmcnt(6)
  v_mfma_f32_32x32x16_bf16 v[32:47], v[152:155], v[220:223], v[32:47]
  v_exp_f32 v64, v64
  v_mul_f32 v74, v66, v74
  v_mul_f32 v66, v66, v10
  buffer_load_dwordx4 v[252:255], v2, s[8:11], s31 offen offset:2048 sc1
  ds_read_b128 v[152:155], v156 offset:12288
  s_waitcnt vmcnt(20) lgkmcnt(6)
  v_mfma_f32_32x32x16_bf16 v[96:111], v[128:131], v[224:227], v[96:111]
  v_exp_f32 v65, v65
  v_fma_f32 v64, v64, v11, v11
  v_mul_f32 v75, v67, v75
  ds_read_b128 v[128:131], v157 offset:12288
  s_waitcnt lgkmcnt(6)
  v_mfma_f32_32x32x16_bf16 v[112:127], v[132:135], v[224:227], v[112:127]
  v_mul_f32 v67, v67, v10
  v_exp_f32 v66, v66
  v_fma_f32 v65, v65, v11, v11
  ds_read_b128 v[132:135], v158 offset:12288
  s_waitcnt lgkmcnt(6)
  v_mfma_f32_32x32x16_bf16 v[32:47], v[136:139], v[224:227], v[32:47]
  v_rcp_f32 v64, v64
  v_mul_f32 v76, v68, v76
  v_mul_f32 v68, v68, v10
  buffer_load_dwordx4 v[204:207], v2, s[8:11], s31 offen offset:3072 sc1
  ds_read_b128 v[136:139], v156 offset:14336
  s_waitcnt vmcnt(20) lgkmcnt(6)
  v_mfma_f32_32x32x16_bf16 v[96:111], v[140:143], v[228:231], v[96:111]
  v_exp_f32 v67, v67
  v_fma_f32 v66, v66, v11, v11
  ds_read_b128 v[140:143], v157 offset:14336
  s_waitcnt lgkmcnt(6)
  v_mfma_f32_32x32x16_bf16 v[112:127], v[144:147], v[228:231], v[112:127]
  v_rcp_f32 v65, v65
  v_mul_f32 v72, v72, v64
  v_mul_f32 v77, v69, v77
  ds_read_b128 v[144:147], v158 offset:14336
  s_waitcnt vmcnt(2)
  s_mov_b64 exec, 3
  s_cmp_lg_u32 s61, 0
  s_cbranch_scc0 DS_kz_ker_36
  buffer_store_dwordx2 v[0:1], v5, s[8:11], s18 offen
DB_kz_ker_37:
  s_mov_b64 exec, -1
  s_waitcnt lgkmcnt(6)
  v_mfma_f32_32x32x16_bf16 v[32:47], v[148:151], v[228:231], v[32:47]
  v_mul_f32 v69, v69, v10
  v_exp_f32 v68, v68
  v_fma_f32 v67, v67, v11, v11
  s_add_u32 s31, s31, 0x1000
  buffer_load_dwordx4 v[208:211], v2, s[8:11], s31 offen offset:0 sc1
  ds_read_b128 v[148:151], v156 offset:16384
  s_waitcnt lgkmcnt(6)
  v_mfma_f32_32x32x16_bf16 v[96:111], v[152:155], v[232:235], v[96:111]
  v_rcp_f32 v66, v66
  v_mul_f32 v73, v73, v65
  v_mul_f32 v78, v70, v78
  ds_read_b128 v[152:155], v157 offset:16384
  s_waitcnt lgkmcnt(6)
  v_mfma_f32_32x32x16_bf16 v[112:127], v[128:131], v[232:235], v[112:127]
  v_mul_f32 v70, v70, v10
  v_exp_f32 v69, v69
  v_fma_f32 v68, v68, v11, v11
  ds_read_b128 v[128:131], v158 offset:16384
  s_waitcnt lgkmcnt(6)
  v_mfma_f32_32x32x16_bf16 v[32:47], v[132:135], v[232:235], v[32:47]
  v_rcp_f32 v67, v67
  v_mul_f32 v74, v74, v66
  v_cvt_pk_bf16_f32 v64, v72, v73
  buffer_load_dwordx4 v[212:215], v2, s[8:11], s31 offen offset:1024 sc1
  ds_read_b128 v[132:135], v156 offset:18432
  s_waitcnt lgkmcnt(6)
  v_mfma_f32_32x32x16_bf16 v[96:111], v[136:139], v[236:239], v[96:111]
  v_mul_f32 v79, v71, v79
  v_mul_f32 v71, v71, v10
  v_exp_f32 v70, v70
  buffer_load_dwordx4 v[216:219], v2, s[8:11], s31 offen offset:2048 sc1
  ds_read_b128 v[136:139], v157 offset:18432
  s_waitcnt lgkmcnt(6)
  v_mfma_f32_32x32x16_bf16 v[112:127], v[140:143], v[236:239], v[112:127]
  v_fma_f32 v69, v69, v11, v11
  v_rcp_f32 v68, v68
  v_mul_f32 v75, v75, v67
  buffer_load_dwordx4 v[220:223], v2, s[8:11], s31 offen offset:3072 sc1
  ds_read_b128 v[140:143], v158 offset:18432
  s_waitcnt lgkmcnt(6)
  v_mfma_f32_32x32x16_bf16 v[32:47], v[144:147], v[236:239], v[32:47]
  v_exp_f32 v71, v71
  v_fma_f32 v70, v70, v11, v11
  s_add_u32 s31, s31, 0x1000
  buffer_load_dwordx4 v[224:227], v2, s[8:11], s31 offen offset:0 sc1
  ds_read_b128 v[144:147], v156 offset:20480
  s_waitcnt lgkmcnt(6)
  v_mfma_f32_32x32x16_bf16 v[96:111], v[148:151], v[160:163], v[96:111]
  v_rcp_f32 v69, v69
  v_mul_f32 v76, v76, v68
  v_cvt_pk_bf16_f32 v65, v74, v75
  buffer_load_dwordx4 v[228:231], v2, s[8:11], s31 offen offset:1024 sc1
  ds_read_b128 v[148:151], v156 offset:22528
  s_waitcnt lgkmcnt(6)
  v_mfma_f32_32x32x16_bf16 v[112:127], v[152:155], v[160:163], v[112:127]
  v_fma_f32 v71, v71, v11, v11
  v_rcp_f32 v70, v70
  v_mul_f32 v77, v77, v69
  buffer_load_dwordx4 v[232:235], v2, s[8:11], s31 offen offset:2048 sc1
  ds_read_b128 v[152:155], v156 offset:24576
  s_waitcnt lgkmcnt(6)
  v_mfma_f32_32x32x16_bf16 v[32:47], v[128:131], v[160:163], v[32:47]
  v_rcp_f32 v71, v71
  v_mul_f32 v78, v78, v70
  v_cvt_pk_bf16_f32 v66, v76, v77
  buffer_load_dwordx4 v[236:239], v2, s[8:11], s31 offen offset:3072 sc1
  ds_read_b128 v[128:131], v156 offset:26624
  s_waitcnt lgkmcnt(6)
  v_mfma_f32_32x32x16_bf16 v[96:111], v[132:135], v[164:167], v[96:111]
  v_mul_f32 v79, v79, v71
  v_cvt_pk_bf16_f32 v67, v78, v79
  s_cmp_lg_u32 s61, 0
  s_cbranch_scc0 DS_kz_ker_38
  buffer_store_dwordx4 v[64:67], v2, s[8:11], s16 offen
DB_kz_ker_39:
  s_add_u32 s16, s16, 0x1000
  ds_read_b128 v[132:135], v156 offset:28672
  s_waitcnt lgkmcnt(6)
  v_mfma_f32_32x32x16_bf16 v[112:127], v[136:139], v[164:167], v[112:127]
  v_mul_f32 v88, v80, v88
  v_mul_f32 v80, v80, v10
  v_mul_f32 v89, v81, v89
  v_mul_f32 v81, v81, v10
  ds_read_b128 v[136:139], v156 offset:30720
  s_waitcnt lgkmcnt(6)
  v_mfma_f32_32x32x16_bf16 v[32:47], v[140:143], v[164:167], v[32:47]
  v_exp_f32 v80, v80
  v_mul_f32 v90, v82, v90
  v_mul_f32 v82, v82, v10
  ds_read_b128 v[140:143], v156 offset:32768
  s_waitcnt lgkmcnt(6)
  v_mfma_f32_32x32x16_bf16 v[96:111], v[144:147], v[180:183], v[96:111]
  v_exp_f32 v81, v81
  v_fma_f32 v80, v80, v11, v11
  v_mul_f32 v91, v83, v91
  ds_read_b128 v[144:147], v156 offset:34816
  s_waitcnt lgkmcnt(6)
  v_mfma_f32_32x32x16_bf16 v[96:111], v[148:151], v[184:187], v[96:111]
  v_mul_f32 v83, v83, v10
  v_exp_f32 v82, v82
  v_fma_f32 v81, v81, v11, v11
  ds_read_b128 v[148:151], v156 offset:36864
  s_waitcnt lgkmcnt(6)
  v_mfma_f32_32x32x16_bf16 v[96:111], v[152:155], v[188:191], v[96:111]
  v_rcp_f32 v80, v80
  v_mul_f32 v92, v84, v92
  v_mul_f32 v84, v84, v10
  ds_read_b128 v[152:155], v156 offset:38912
  s_waitcnt lgkmcnt(6)
  v_mfma_f32_32x32x16_bf16 v[96:111], v[128:131], v[192:195], v[96:111]
  v_exp_f32 v83, v83
  v_fma_f32 v82, v82, v11, v11
  ds_read_b128 v[128:131], v156 offset:40960
  s_waitcnt lgkmcnt(6)
  v_mfma_f32_32x32x16_bf16 v[96:111], v[132:135], v[168:171], v[96:111]
  v_rcp_f32 v81, v81
  v_mul_f32 v88, v88, v80
  v_mul_f32 v93, v85, v93
  ds_read_b128 v[132:135], v156 offset:43008
  s_waitcnt lgkmcnt(6)
  v_mfma_f32_32x32x16_bf16 v[96:111], v[136:139], v[172:175], v[96:111]
  v_mul_f32 v85, v85, v10
  v_exp_f32 v84, v84
  v_fma_f32 v83, v83, v11, v11
  ds_read_b128 v[136:139], v156 offset:45056
  s_waitcnt lgkmcnt(6)
  v_mfma_f32_32x32x16_bf16 v[96:111], v[140:143], v[176:179], v[96:111]
  v_rcp_f32 v82, v82
  v_mul_f32 v89, v89, v81
  v_mul_f32 v94, v86, v94
  ds_read_b128 v[140:143], v156 offset:47104
  s_waitcnt lgkmcnt(6)
  v_mfma_f32_32x32x16_bf16 v[96:111], v[144:147], v[196:199], v[96:111]
  v_mul_f32 v86, v86, v10
  v_exp_f32 v85, v85
  v_fma_f32 v84, v84, v11, v11
  ds_read_b128 v[144:147], v156 offset:49152
  s_waitcnt lgkmcnt(6)
  v_mfma_f32_32x32x16_bf16 v[96:111], v[148:151], v[200:203], v[96:111]
  v_rcp_f32 v83, v83
  v_mul_f32 v90, v90, v82
  v_cvt_pk_bf16_f32 v80, v88, v89
  ds_read_b128 v[148:151], v156 offset:51200
  s_waitcnt lgkmcnt(6)
  v_mfma_f32_32x32x16_bf16 v[96:111], v[152:155], v[240:243], v[96:111]
  v_mul_f32 v95, v87, v95
  v_mul_f32 v87, v87, v10
  v_exp_f32 v86, v86
  ds_read_b128 v[152:155], v156 offset:53248
  s_waitcnt lgkmcnt(6)
  v_mfma_f32_32x32x16_bf16 v[96:111], v[128:131], v[244:247], v[96:111]
  v_fma_f32 v85, v85, v11, v11
  v_rcp_f32 v84, v84
  v_mul_f32 v91, v91, v83
  ds_read_b128 v[128:131], v156 offset:55296
  s_waitcnt lgkmcnt(6)
  v_mfma_f32_32x32x16_bf16 v[96:111], v[132:135], v[248:251], v[96:111]
  v_exp_f32 v87, v87
  v_fma_f32 v86, v86, v11, v11
  ds_read_b128 v[132:135], v156 offset:57344
  s_waitcnt vmcnt(11) lgkmcnt(6)
  v_mfma_f32_32x32x16_bf16 v[96:111], v[136:139], v[252:255], v[96:111]
  v_rcp_f32 v85, v85
  v_mul_f32 v92, v92, v84
  v_cvt_pk_bf16_f32 v81, v90, v91
  ds_read_b128 v[136:139], v156 offset:59392
  s_waitcnt vmcnt(10) lgkmcnt(6)
  v_mfma_f32_32x32x16_bf16 v[96:111], v[140:143], v[204:207], v[96:111]
  v_fma_f32 v87, v87, v11, v11
  v_rcp_f32 v86, v86
  v_mul_f32 v93, v93, v85
  ds_read_b128 v[140:143], v156 offset:61440
  s_waitcnt vmcnt(8) lgkmcnt(6)
  v_mfma_f32_32x32x16_bf16 v[96:111], v[144:147], v[208:211], v[96:111]
  v_rcp_f32 v87, v87
  v_mul_f32 v94, v94, v86
  v_cvt_pk_bf16_f32 v82, v92, v93
  ds_read_b128 v[144:147], v156 offset:63488
  s_waitcnt vmcnt(7) lgkmcnt(6)
  v_mfma_f32_32x32x16_bf16 v[96:111], v[148:151], v[212:215], v[96:111]
  v_mul_f32 v95, v95, v87
  v_cvt_pk_bf16_f32 v83, v94, v95
  s_cmp_lg_u32 s61, 0
  s_cbranch_scc0 DS_kz_ker_40
  buffer_store_dwordx4 v[80:83], v2, s[8:11], s16 offen
DB_kz_ker_41:
  s_waitcnt vmcnt(7) lgkmcnt(5)
  v_mfma_f32_32x32x16_bf16 v[96:111], v[152:155], v[216:219], v[96:111]
  ds_read_b128 v[148:151], v157 offset:20480
  s_waitcnt vmcnt(6) lgkmcnt(5)
  v_mfma_f32_32x32x16_bf16 v[96:111], v[128:131], v[220:223], v[96:111]
  ds_read_b128 v[152:155], v157 offset:22528
  s_waitcnt vmcnt(5) lgkmcnt(5)
  v_mfma_f32_32x32x16_bf16 v[96:111], v[132:135], v[224:227], v[96:111]
  ds_read_b128 v[128:131], v157 offset:24576
  s_waitcnt vmcnt(4) lgkmcnt(5)
  v_mfma_f32_32x32x16_bf16 v[96:111], v[136:139], v[228:231], v[96:111]
  ds_read_b128 v[132:135], v157 offset:26624
  s_waitcnt vmcnt(3) lgkmcnt(5)
  v_mfma_f32_32x32x16_bf16 v[96:111], v[140:143], v[232:235], v[96:111]
  ds_read_b128 v[136:139], v157 offset:28672
  s_waitcnt vmcnt(2) lgkmcnt(5)
  v_mfma_f32_32x32x16_bf16 v[96:111], v[144:147], v[236:239], v[96:111]
  ds_read_b128 v[140:143], v157 offset:30720
  v_mfma_f32_32x32x16_bf16 v[96:111], v[16:19], v[22:25], v[96:111]
  ds_read_b128 v[144:147], v157 offset:32768
  s_waitcnt vmcnt(0)
  s_mov_b64 exec, 12
  s_cmp_lg_u32 s61, 0
  s_cbranch_scc0 DS_kz_ker_42
  buffer_store_dwordx2 v[0:1], v5, s[8:11], s18 offen
DB_kz_ker_43:
  s_mov_b64 exec, -1
  s_waitcnt lgkmcnt(6)
  v_mfma_f32_32x32x16_bf16 v[112:127], v[148:151], v[180:183], v[112:127]
  ds_read_b128 v[148:151], v157 offset:34816
  s_waitcnt lgkmcnt(6)
  v_mfma_f32_32x32x16_bf16 v[112:127], v[152:155], v[184:187], v[112:127]
  v_mul_f32 v104, v96, v104
  v_mul_f32 v96, v96, v30
  v_mul_f32 v105, v97, v105
  v_mul_f32 v97, v97, v30
  ds_read_b128 v[152:155], v157 offset:36864
  s_waitcnt lgkmcnt(6)
  v_mfma_f32_32x32x16_bf16 v[112:127], v[128:131], v[188:191], v[112:127]
  v_exp_f32 v96, v96
  v_mul_f32 v106, v98, v106
  v_mul_f32 v98, v98, v30
  ds_read_b128 v[128:131], v157 offset:38912
  s_waitcnt lgkmcnt(6)
  v_mfma_f32_32x32x16_bf16 v[112:127], v[132:135], v[192:195], v[112:127]
  v_exp_f32 v97, v97
  v_fma_f32 v96, v96, v31, v31
  v_mul_f32 v107, v99, v107
  ds_read_b128 v[132:135], v157 offset:40960
  s_waitcnt lgkmcnt(6)
  v_mfma_f32_32x32x16_bf16 v[112:127], v[136:139], v[168:171], v[112:127]
  v_mul_f32 v99, v99, v30
  v_exp_f32 v98, v98
  v_fma_f32 v97, v97, v31, v31
  ds_read_b128 v[136:139], v157 offset:43008
  s_waitcnt lgkmcnt(6)
  v_mfma_f32_32x32x16_bf16 v[112:127], v[140:143], v[172:175], v[112:127]
  v_rcp_f32 v96, v96
  v_mul_f32 v108, v100, v108
  v_mul_f32 v100, v100, v30
  ds_read_b128 v[140:143], v157 offset:45056
  s_waitcnt lgkmcnt(6)
  v_mfma_f32_32x32x16_bf16 v[112:127], v[144:147], v[176:179], v[112:127]
  v_exp_f32 v99, v99
  v_fma_f32 v98, v98, v31, v31
  ds_read_b128 v[144:147], v157 offset:47104
  s_waitcnt lgkmcnt(6)
  v_mfma_f32_32x32x16_bf16 v[112:127], v[148:151], v[196:199], v[112:127]
  v_rcp_f32 v97, v97
  v_mul_f32 v104, v104, v96
  v_mul_f32 v109, v101, v109
  ds_read_b128 v[148:151], v157 offset:49152
  s_waitcnt lgkmcnt(6)
  v_mfma_f32_32x32x16_bf16 v[112:127], v[152:155], v[200:203], v[112:127]
  v_mul_f32 v101, v101, v30
  v_exp_f32 v100, v100
  v_fma_f32 v99, v99, v31, v31
  ds_read_b128 v[152:155], v157 offset:51200
  s_waitcnt lgkmcnt(6)
  v_mfma_f32_32x32x16_bf16 v[112:127], v[128:131], v[240:243], v[112:127]
  v_rcp_f32 v98, v98
  v_mul_f32 v105, v105, v97
  v_mul_f32 v110, v102, v110
  ds_read_b128 v[128:131], v157 offset:53248
  s_waitcnt lgkmcnt(6)
  v_mfma_f32_32x32x16_bf16 v[112:127], v[132:135], v[244:247], v[112:127]
  v_mul_f32 v102, v102, v30
  v_exp_f32 v101, v101
  v_fma_f32 v100, v100, v31, v31
  ds_read_b128 v[132:135], v157 offset:55296
  s_waitcnt lgkmcnt(6)
  v_mfma_f32_32x32x16_bf16 v[112:127], v[136:139], v[248:251], v[112:127]
  v_rcp_f32 v99, v99
  v_mul_f32 v106, v106, v98
  v_cvt_pk_bf16_f32 v96, v104, v105
  ds_read_b128 v[136:139], v157 offset:57344
  s_waitcnt lgkmcnt(6)
  v_mfma_f32_32x32x16_bf16 v[112:127], v[140:143], v[252:255], v[112:127]
  v_mul_f32 v111, v103, v111
  v_mul_f32 v103, v103, v30
  v_exp_f32 v102, v102
  ds_read_b128 v[140:143], v157 offset:59392
  s_waitcnt lgkmcnt(6)
  v_mfma_f32_32x32x16_bf16 v[112:127], v[144:147], v[204:207], v[112:127]
  v_fma_f32 v101, v101, v31, v31
  v_rcp_f32 v100, v100
  v_mul_f32 v107, v107, v99
  ds_read_b128 v[144:147], v157 offset:61440
  s_waitcnt lgkmcnt(6)
  v_mfma_f32_32x32x16_bf16 v[112:127], v[148:151], v[208:211], v[112:127]
  v_exp_f32 v103, v103
  v_fma_f32 v102, v102, v31, v31
  ds_read_b128 v[148:151], v157 offset:63488
  s_waitcnt lgkmcnt(6)
  v_mfma_f32_32x32x16_bf16 v[112:127], v[152:155], v[212:215], v[112:127]
  v_rcp_f32 v101, v101
  v_mul_f32 v108, v108, v100
  v_cvt_pk_bf16_f32 v97, v106, v107
  s_waitcnt lgkmcnt(5)
  v_mfma_f32_32x32x16_bf16 v[112:127], v[128:131], v[216:219], v[112:127]
  v_fma_f32 v103, v103, v31, v31
  v_rcp_f32 v102, v102
  v_mul_f32 v109, v109, v101
  ds_read_b128 v[152:155], v158 offset:20480
  s_waitcnt lgkmcnt(5)
  v_mfma_f32_32x32x16_bf16 v[112:127], v[132:135], v[220:223], v[112:127]
  v_rcp_f32 v103, v103
  v_mul_f32 v110, v110, v102
  v_cvt_pk_bf16_f32 v98, v108, v109
  ds_read_b128 v[128:131], v158 offset:22528
  s_waitcnt lgkmcnt(5)
  v_mfma_f32_32x32x16_bf16 v[112:127], v[136:139], v[224:227], v[112:127]
  v_mul_f32 v111, v111, v103
  v_cvt_pk_bf16_f32 v99, v110, v111
  s_cmp_lg_u32 s61, 0
  s_cbranch_scc0 DS_kz_ker_44
  buffer_store_dwordx4 v[96:99], v2, s[8:11], s17 offen
DB_kz_ker_45:
  s_add_u32 s17, s17, 0x1000
  ds_read_b128 v[132:135], v158 offset:24576
  s_waitcnt lgkmcnt(5)
  v_mfma_f32_32x32x16_bf16 v[112:127], v[140:143], v[228:231], v[112:127]
  ds_read_b128 v[136:139], v158 offset:26624
  s_waitcnt lgkmcnt(5)
  v_mfma_f32_32x32x16_bf16 v[112:127], v[144:147], v[232:235], v[112:127]
  ds_read_b128 v[140:143], v158 offset:28672
  s_waitcnt lgkmcnt(5)
  v_mfma_f32_32x32x16_bf16 v[112:127], v[148:151], v[236:239], v[112:127]
  ds_read_b128 v[144:147], v158 offset:30720
  v_mfma_f32_32x32x16_bf16 v[112:127], v[16:19], v[26:29], v[112:127]
  ds_read_b128 v[148:151], v158 offset:32768
  s_waitcnt lgkmcnt(6)
  v_mfma_f32_32x32x16_bf16 v[32:47], v[152:155], v[180:183], v[32:47]
  ds_read_b128 v[152:155], v158 offset:34816
  s_waitcnt lgkmcnt(6)
  v_mfma_f32_32x32x16_bf16 v[32:47], v[128:131], v[184:187], v[32:47]
  s_nop 5
  v_mul_f32 v120, v112, v120
  v_mul_f32 v112, v112, v30
  v_mul_f32 v121, v113, v121
  v_mul_f32 v113, v113, v30
  ds_read_b128 v[128:131], v158 offset:36864
  s_waitcnt lgkmcnt(6)
  v_mfma_f32_32x32x16_bf16 v[32:47], v[132:135], v[188:191], v[32:47]
  v_exp_f32 v112, v112
  v_mul_f32 v122, v114, v122
  v_mul_f32 v114, v114, v30
  ds_read_b128 v[132:135], v158 offset:38912
  s_waitcnt vmcnt(0)
  s_cmp_lg_u32 s61, 0
  s_cbranch_scc0 DS_kz_ker_46
  buffer_store_dwordx2 v[0:1], off, s[8:11], s19 offset:0
DB_kz_ker_47:
  s_waitcnt lgkmcnt(6)
  v_mfma_f32_32x32x16_bf16 v[32:47], v[136:139], v[192:195], v[32:47]
  v_exp_f32 v113, v113
  v_fma_f32 v112, v112, v31, v31
  v_mul_f32 v123, v115, v123
  ds_read_b128 v[136:139], v158 offset:40960
  s_waitcnt lgkmcnt(6)
  v_mfma_f32_32x32x16_bf16 v[32:47], v[140:143], v[168:171], v[32:47]
  v_mul_f32 v115, v115, v30
  v_exp_f32 v114, v114
  v_fma_f32 v113, v113, v31, v31
  ds_read_b128 v[140:143], v158 offset:43008
  s_waitcnt lgkmcnt(6)
  v_mfma_f32_32x32x16_bf16 v[32:47], v[144:147], v[172:175], v[32:47]
  v_rcp_f32 v112, v112
  v_mul_f32 v124, v116, v124
  v_mul_f32 v116, v116, v30
  ds_read_b128 v[144:147], v158 offset:45056
  s_waitcnt lgkmcnt(6)
  v_mfma_f32_32x32x16_bf16 v[32:47], v[148:151], v[176:179], v[32:47]
  v_exp_f32 v115, v115
  v_fma_f32 v114, v114, v31, v31
  ds_read_b128 v[148:151], v158 offset:47104
  s_waitcnt lgkmcnt(6)
  v_mfma_f32_32x32x16_bf16 v[32:47], v[152:155], v[196:199], v[32:47]
  v_rcp_f32 v113, v113
  v_mul_f32 v120, v120, v112
  v_mul_f32 v125, v117, v125
  ds_read_b128 v[152:155], v158 offset:49152
  s_waitcnt lgkmcnt(6)
  v_mfma_f32_32x32x16_bf16 v[32:47], v[128:131], v[200:203], v[32:47]
  v_mul_f32 v117, v117, v30
  v_exp_f32 v116, v116
  v_fma_f32 v115, v115, v31, v31
  ds_read_b128 v[128:131], v158 offset:51200
  s_waitcnt lgkmcnt(6)
  v_mfma_f32_32x32x16_bf16 v[32:47], v[132:135], v[240:243], v[32:47]
  v_rcp_f32 v114, v114
  v_mul_f32 v121, v121, v113
  v_mul_f32 v126, v118, v126
  ds_read_b128 v[132:135], v158 offset:53248
  s_waitcnt lgkmcnt(6)
  v_mfma_f32_32x32x16_bf16 v[32:47], v[136:139], v[244:247], v[32:47]
  v_mul_f32 v118, v118, v30
  v_exp_f32 v117, v117
  v_fma_f32 v116, v116, v31, v31
  ds_read_b128 v[136:139], v158 offset:55296
  s_waitcnt lgkmcnt(6)
  v_mfma_f32_32x32x16_bf16 v[32:47], v[140:143], v[248:251], v[32:47]
  v_rcp_f32 v115, v115
  v_mul_f32 v122, v122, v114
  v_cvt_pk_bf16_f32 v112, v120, v121
  ds_read_b128 v[140:143], v158 offset:57344
  s_waitcnt lgkmcnt(6)
  v_mfma_f32_32x32x16_bf16 v[32:47], v[144:147], v[252:255], v[32:47]
  v_mul_f32 v127, v119, v127
  v_mul_f32 v119, v119, v30
  v_exp_f32 v118, v118
  ds_read_b128 v[144:147], v158 offset:59392
  s_waitcnt lgkmcnt(6)
  v_mfma_f32_32x32x16_bf16 v[32:47], v[148:151], v[204:207], v[32:47]
  v_fma_f32 v117, v117, v31, v31
  v_rcp_f32 v116, v116
  v_mul_f32 v123, v123, v115
  ds_read_b128 v[148:151], v158 offset:61440
  s_waitcnt lgkmcnt(6)
  v_mfma_f32_32x32x16_bf16 v[32:47], v[152:155], v[208:211], v[32:47]
  v_exp_f32 v119, v119
  v_fma_f32 v118, v118, v31, v31
  ds_read_b128 v[152:155], v158 offset:63488
  s_waitcnt lgkmcnt(6)
  v_mfma_f32_32x32x16_bf16 v[32:47], v[128:131], v[212:215], v[32:47]
  v_rcp_f32 v117, v117
  v_mul_f32 v124, v124, v116
  v_cvt_pk_bf16_f32 v113, v122, v123
  s_waitcnt lgkmcnt(5)
  v_mfma_f32_32x32x16_bf16 v[32:47], v[132:135], v[216:219], v[32:47]
  v_fma_f32 v119, v119, v31, v31
  v_rcp_f32 v118, v118
  v_mul_f32 v125, v125, v117
  s_waitcnt lgkmcnt(4)
  v_mfma_f32_32x32x16_bf16 v[32:47], v[136:139], v[220:223], v[32:47]
  v_rcp_f32 v119, v119
  v_mul_f32 v126, v126, v118
  v_cvt_pk_bf16_f32 v114, v124, v125
  s_waitcnt lgkmcnt(3)
  v_mfma_f32_32x32x16_bf16 v[32:47], v[140:143], v[224:227], v[32:47]
  v_mul_f32 v127, v127, v119
  v_cvt_pk_bf16_f32 v115, v126, v127
  s_cmp_lg_u32 s61, 0
  s_cbranch_scc0 DS_kz_ker_48
  buffer_store_dwordx4 v[112:115], v2, s[8:11], s17 offen
DB_kz_ker_49:
  s_add_u32 s17, s17, 0x1000
  s_waitcnt lgkmcnt(2)
  v_mfma_f32_32x32x16_bf16 v[32:47], v[144:147], v[228:231], v[32:47]
  s_waitcnt lgkmcnt(1)
  v_mfma_f32_32x32x16_bf16 v[32:47], v[148:151], v[232:235], v[32:47]
  s_waitcnt lgkmcnt(0)
  v_mfma_f32_32x32x16_bf16 v[32:47], v[152:155], v[236:239], v[32:47]
  v_mfma_f32_32x32x16_bf16 v[32:47], v[16:19], v[20:23], v[32:47]
  s_nop 11
  v_mul_f32 v40, v32, v40
  v_mul_f32 v32, v32, v30
  v_mul_f32 v41, v33, v41
  v_mul_f32 v33, v33, v30
  v_exp_f32 v32, v32
  v_mul_f32 v42, v34, v42
  v_mul_f32 v34, v34, v30
  v_exp_f32 v33, v33
  v_fma_f32 v32, v32, v31, v31
  v_mul_f32 v43, v35, v43
  v_mul_f32 v35, v35, v30
  v_exp_f32 v34, v34
  v_fma_f32 v33, v33, v31, v31
  v_rcp_f32 v32, v32
  v_mul_f32 v44, v36, v44
  v_mul_f32 v36, v36, v30
  v_exp_f32 v35, v35
  v_fma_f32 v34, v34, v31, v31
  v_rcp_f32 v33, v33
  v_mul_f32 v40, v40, v32
  v_mul_f32 v45, v37, v45
  v_mul_f32 v37, v37, v30
  v_exp_f32 v36, v36
  v_fma_f32 v35, v35, v31, v31
  s_waitcnt vmcnt(0)
  s_cmp_lg_u32 s61, 0
  s_cbranch_scc0 DS_kz_ker_50
  buffer_store_dwordx2 v[0:1], off, s[8:11], s19 offset:32
DB_kz_ker_51:
  v_rcp_f32 v34, v34
  v_mul_f32 v41, v41, v33
  v_mul_f32 v46, v38, v46
  v_mul_f32 v38, v38, v30
  v_exp_f32 v37, v37
  v_fma_f32 v36, v36, v31, v31
  v_rcp_f32 v35, v35
  v_mul_f32 v42, v42, v34
  v_cvt_pk_bf16_f32 v32, v40, v41
  v_mul_f32 v47, v39, v47
  v_mul_f32 v39, v39, v30
  v_exp_f32 v38, v38
  v_fma_f32 v37, v37, v31, v31
  v_rcp_f32 v36, v36
  v_mul_f32 v43, v43, v35
  v_exp_f32 v39, v39
  v_fma_f32 v38, v38, v31, v31
  v_rcp_f32 v37, v37
  v_mul_f32 v44, v44, v36
  v_cvt_pk_bf16_f32 v33, v42, v43
  v_fma_f32 v39, v39, v31, v31
  v_rcp_f32 v38, v38
  v_mul_f32 v45, v45, v37
  v_rcp_f32 v39, v39
  v_mul_f32 v46, v46, v38
  v_cvt_pk_bf16_f32 v34, v44, v45
  v_mul_f32 v47, v47, v39
  v_cvt_pk_bf16_f32 v35, v46, v47
  s_cmp_lg_u32 s61, 0
  s_cbranch_scc0 DS_kz_ker_52
  buffer_store_dwordx4 v[32:35], v2, s[8:11], s17 offen
DB_kz_ker_53:
  s_waitcnt vmcnt(0)
  s_cmp_lg_u32 s61, 0
  s_cbranch_scc0 DS_kz_ker_54
  buffer_store_dwordx2 v[0:1], off, s[8:11], s19 offset:64
DB_kz_ker_55:
  s_branch END_kz_ker_2
OOL_kz_ker_8:
  s_cmp_lg_u32 s49, 27
  s_cbranch_scc1 SP_kz_ker_57
  s_waitcnt vmcnt(0)
  v_lshlrev_b32 v0, 3, v1
  buffer_load_dwordx2 v[0:1], v0, s[8:11], s35 offen sc1
SP_kz_ker_57:
  ds_read_b32 v6, v5 offset:1024
  s_waitcnt lgkmcnt(0)
  v_readfirstlane_b32 s52, v6
  s_bitcmp1_b32 s52, s49
  s_cbranch_scc1 BACK_kz_ker_9
  s_sleep 1
  s_sub_u32 s60, s60, 1
  s_cbranch_scc0 SP_kz_ker_57
  s_mov_b32 s60, 0
  s_branch BACK_kz_ker_9
SLOW_kz_ker_6:
  v_mov_b32 v115, 0xff800000
  v_mov_b32 v116, 0xff800000
  s_add_u32 s52, s28, 0x200000
  s_mov_b32 s49, 64
SL_kz_ker_58:
  buffer_load_dwordx4 v[128:131], v2, s[8:11], s52 offen sc1
  s_waitcnt vmcnt(0)
  v_mfma_f32_32x32x16_bf16 v[80:95], v[128:131], v[8:11], 0
  v_mfma_f32_32x32x16_bf16 v[96:111], v[128:131], v[12:15], 0
  s_nop 10
  v_max3_f32 v115, v80, v81, v115
  v_max_f32 v115, v115, v82
  v_max3_f32 v117, v83, v84, v85
  v_max3_f32 v115, v115, v86, v87
  v_max3_f32 v117, v117, v88, v89
  v_max3_f32 v115, v115, v90, v91
  v_max3_f32 v117, v117, v92, v93
  v_max3_f32 v115, v115, v94, v95
  v_max_f32 v115, v115, v117
  v_max3_f32 v116, v96, v97, v116
  v_max_f32 v116, v116, v98
  v_max3_f32 v117, v99, v100, v101
  v_max3_f32 v116, v116, v102, v103
  v_max3_f32 v117, v117, v104, v105
  v_max3_f32 v116, v116, v106, v107
  v_max3_f32 v117, v117, v108, v109
  v_max3_f32 v116, v116, v110, v111
  v_max_f32 v116, v116, v117
  s_add_u32 s52, s52, 0x400
  s_sub_u32 s49, s49, 1
  s_cmp_lg_u32 s49, 0
  s_cbranch_scc1 SL_kz_ker_58
  v_mov_b32 v114, v115
  s_nop 1
  v_permlane32_swap_b32 v114, v115
  v_max_f32 v115, v115, v114
  v_sub_f32 v16, 0, v115
  v_mov_b32 v17, v16
  v_mov_b32 v18, v16
  v_mov_b32 v19, v16
  v_mov_b32 v20, v16
  v_mov_b32 v21, v16
  v_mov_b32 v22, v16
  v_mov_b32 v23, v16
  v_mov_b32 v24, v16
  v_mov_b32 v25, v16
  v_mov_b32 v26, v16
  v_mov_b32 v27, v16
  v_mov_b32 v28, v16
  v_mov_b32 v29, v16
  v_mov_b32 v30, v16
  v_mov_b32 v31, v16
  v_mov_b32 v114, v116
  s_nop 1
  v_permlane32_swap_b32 v114, v116
  v_max_f32 v116, v116, v114
  v_sub_f32 v32, 0, v116
  v_mov_b32 v33, v32
  v_mov_b32 v34, v32
  v_mov_b32 v35, v32
  v_mov_b32 v36, v32
  v_mov_b32 v37, v32
  v_mov_b32 v38, v32
  v_mov_b32 v39, v32
  v_mov_b32 v40, v32
  v_mov_b32 v41, v32
  v_mov_b32 v42, v32
  v_mov_b32 v43, v32
  v_mov_b32 v44, v32
  v_mov_b32 v45, v32
  v_mov_b32 v46, v32
  v_mov_b32 v47, v32
  v_mov_b32 v48, 0
  v_mov_b32 v49, 0
  v_mov_b32 v50, 0
  v_mov_b32 v51, 0
  v_mov_b32 v52, 0
  v_mov_b32 v53, 0
  v_mov_b32 v54, 0
  v_mov_b32 v55, 0
  v_mov_b32 v56, 0
  v_mov_b32 v57, 0
  v_mov_b32 v58, 0
  v_mov_b32 v59, 0
  v_mov_b32 v60, 0
  v_mov_b32 v61, 0
  v_mov_b32 v62, 0
  v_mov_b32 v63, 0
  v_mov_b32 v64, 0
  v_mov_b32 v65, 0
  v_mov_b32 v66, 0
  v_mov_b32 v67, 0
  v_mov_b32 v68, 0
  v_mov_b32 v69, 0
  v_mov_b32 v70, 0
  v_mov_b32 v71, 0
  v_mov_b32 v72, 0
  v_mov_b32 v73, 0
  v_mov_b32 v74, 0
  v_mov_b32 v75, 0
  v_mov_b32 v76, 0
  v_mov_b32 v77, 0
  v_mov_b32 v78, 0
  v_mov_b32 v79, 0
  v_and_b32 v4, 0x3ff, v4
  s_add_u32 s52, s28, 0x200000
  s_add_u32 s53, s28, 0x400000
  s_mov_b32 s49, 64
S2_kz_ker_59:
  buffer_load_dwordx4 v[128:131], v2, s[8:11], s52 offen sc1
  s_mov_b64 exec, s[50:51]
  s_waitcnt lgkmcnt(4)
  buffer_load_dwordx4 v[144:147], v4, s[8:11], s53 offen sc1
  s_waitcnt lgkmcnt(3)
  buffer_load_dwordx4 v[148:151], v4, s[8:11], s53 offen offset:512 sc1
  s_mov_b64 exec, -1
  s_waitcnt vmcnt(2)
  v_mfma_f32_32x32x16_bf16 v[80:95], v[128:131], v[8:11], v[16:31]
  v_mfma_f32_32x32x16_bf16 v[96:111], v[128:131], v[12:15], v[32:47]
  s_nop 10
  v_exp_f32 v80, v80
  v_exp_f32 v81, v81
  v_exp_f32 v82, v82
  v_exp_f32 v83, v83
  v_exp_f32 v84, v84
  v_exp_f32 v85, v85
  v_exp_f32 v86, v86
  v_exp_f32 v87, v87
  v_exp_f32 v88, v88
  v_exp_f32 v89, v89
  v_exp_f32 v90, v90
  v_exp_f32 v91, v91
  v_exp_f32 v92, v92
  v_exp_f32 v93, v93
  v_exp_f32 v94, v94
  v_exp_f32 v95, v95
  v_cvt_pk_bf16_f32 v112, v80, v81
  v_cvt_pk_bf16_f32 v113, v82, v83
  v_cvt_pk_bf16_f32 v114, v84, v85
  v_cvt_pk_bf16_f32 v115, v86, v87
  v_cvt_pk_bf16_f32 v116, v88, v89
  v_cvt_pk_bf16_f32 v117, v90, v91
  v_cvt_pk_bf16_f32 v118, v92, v93
  v_cvt_pk_bf16_f32 v119, v94, v95
  s_waitcnt vmcnt(1)
  v_mfma_f32_32x32x16_bf16 v[48:63], v[144:147], v[112:115], v[48:63]
  s_waitcnt vmcnt(0)
  v_mfma_f32_32x32x16_bf16 v[48:63], v[148:151], v[116:119], v[48:63]
  v_exp_f32 v96, v96
  v_exp_f32 v97, v97
  v_exp_f32 v98, v98
  v_exp_f32 v99, v99
  v_exp_f32 v100, v100
  v_exp_f32 v101, v101
  v_exp_f32 v102, v102
  v_exp_f32 v103, v103
  v_exp_f32 v104, v104
  v_exp_f32 v105, v105
  v_exp_f32 v106, v106
  v_exp_f32 v107, v107
  v_exp_f32 v108, v108
  v_exp_f32 v109, v109
  v_exp_f32 v110, v110
  v_exp_f32 v111, v111
  v_cvt_pk_bf16_f32 v120, v96, v97
  v_cvt_pk_bf16_f32 v121, v98, v99
  v_cvt_pk_bf16_f32 v122, v100, v101
  v_cvt_pk_bf16_f32 v123, v102, v103
  v_cvt_pk_bf16_f32 v124, v104, v105
  v_cvt_pk_bf16_f32 v125, v106, v107
  v_cvt_pk_bf16_f32 v126, v108, v109
  v_cvt_pk_bf16_f32 v127, v110, v111
  v_mfma_f32_32x32x16_bf16 v[64:79], v[144:147], v[120:123], v[64:79]
  s_nop 0
  v_mfma_f32_32x32x16_bf16 v[64:79], v[148:151], v[124:127], v[64:79]
  s_add_u32 s52, s52, 0x400
  s_add_u32 s53, s53, 0x400
  s_sub_u32 s49, s49, 1
  s_cmp_lg_u32 s49, 0
  s_cbranch_scc1 S2_kz_ker_59
  s_branch FIN_kz_ker_7
PR_kz_ker_10:
  v_lshrrev_b32 v3, 1, v2
PL_kz_ker_60:
  buffer_load_dwordx2 v[0:1], v3, s[8:11], s35 offen sc1
  s_waitcnt vmcnt(0)
  v_and_b32 v0, -16, v0
  v_cmp_eq_u64 vcc, s[56:57], v[0:1]
  s_andn2_b64 s[62:63], -1, vcc
  s_cmp_eq_u64 s[62:63], 0
  s_cbranch_scc1 PD_kz_ker_61
  s_sub_u32 s60, s60, 1
  s_cbranch_scc0 PL_kz_ker_60
  s_mov_b32 s60, 0
PD_kz_ker_61:
  s_branch PRB_kz_ker_11
FL_kz_ker_15:
  buffer_load_dwordx4 v[16:19], v2, s[8:11], s36 offen offset:0 sc1
  buffer_load_dwordx4 v[20:23], v2, s[8:11], s36 offen offset:1024 sc1
  buffer_load_dwordx4 v[24:27], v2, s[8:11], s36 offen offset:2048 sc1
  buffer_load_dwordx4 v[28:31], v2, s[8:11], s36 offen offset:3072 sc1
  s_branch SK_kz_ker_14
FL_kz_ker_17:
  buffer_load_dwordx4 v[32:35], v2, s[8:11], s37 offen offset:0 sc1
  buffer_load_dwordx4 v[36:39], v2, s[8:11], s37 offen offset:1024 sc1
  buffer_load_dwordx4 v[40:43], v2, s[8:11], s37 offen offset:2048 sc1
  buffer_load_dwordx4 v[44:47], v2, s[8:11], s37 offen offset:3072 sc1
  s_branch SK_kz_ker_16
FL_kz_ker_19:
  buffer_load_dwordx4 v[48:51], v2, s[8:11], s38 offen offset:0 sc1
  buffer_load_dwordx4 v[52:55], v2, s[8:11], s38 offen offset:1024 sc1
  buffer_load_dwordx4 v[56:59], v2, s[8:11], s38 offen offset:2048 sc1
  buffer_load_dwordx4 v[60:63], v2, s[8:11], s38 offen offset:3072 sc1
  s_branch SK_kz_ker_18
FL_kz_ker_21:
  buffer_load_dwordx4 v[64:67], v2, s[8:11], s39 offen offset:0 sc1
  buffer_load_dwordx4 v[68:71], v2, s[8:11], s39 offen offset:1024 sc1
  buffer_load_dwordx4 v[72:75], v2, s[8:11], s39 offen offset:2048 sc1
  buffer_load_dwordx4 v[76:79], v2, s[8:11], s39 offen offset:3072 sc1
  s_branch SK_kz_ker_20
DS_kz_ker_22:
  buffer_store_dwordx4 v[168:171], v2, s[8:11], s43 offen sc1
  s_branch DB_kz_ker_23
DS_kz_ker_24:
  buffer_store_dwordx4 v[172:175], v2, s[8:11], s43 offen offset:1024 sc1
  s_branch DB_kz_ker_25
DS_kz_ker_26:
  buffer_store_dwordx2 v[176:177], v8, s[8:11], s44 offen sc1
  s_branch DB_kz_ker_27
DS_kz_ker_28:
  buffer_store_dwordx2 v[0:1], off, s[8:11], s45 sc1
  s_branch DB_kz_ker_29
DS_kz_ker_32:
  buffer_store_dwordx4 v[32:35], v2, s[8:11], s16 offen sc1
  s_branch DB_kz_ker_33
DS_kz_ker_34:
  buffer_store_dwordx4 v[48:51], v2, s[8:11], s16 offen sc1
  s_branch DB_kz_ker_35
DS_kz_ker_36:
  buffer_store_dwordx2 v[0:1], v5, s[8:11], s18 offen sc1
  s_branch DB_kz_ker_37
DS_kz_ker_38:
  buffer_store_dwordx4 v[64:67], v2, s[8:11], s16 offen sc1
  s_branch DB_kz_ker_39
DS_kz_ker_40:
  buffer_store_dwordx4 v[80:83], v2, s[8:11], s16 offen sc1
  s_branch DB_kz_ker_41
DS_kz_ker_42:
  buffer_store_dwordx2 v[0:1], v5, s[8:11], s18 offen sc1
  s_branch DB_kz_ker_43
DS_kz_ker_44:
  buffer_store_dwordx4 v[96:99], v2, s[8:11], s17 offen sc1
  s_branch DB_kz_ker_45
DS_kz_ker_46:
  buffer_store_dwordx2 v[0:1], off, s[8:11], s19 offset:0 sc1
  s_branch DB_kz_ker_47
DS_kz_ker_48:
  buffer_store_dwordx4 v[112:115], v2, s[8:11], s17 offen sc1
  s_branch DB_kz_ker_49
DS_kz_ker_50:
  buffer_store_dwordx2 v[0:1], off, s[8:11], s19 offset:32 sc1
  s_branch DB_kz_ker_51
DS_kz_ker_52:
  buffer_store_dwordx4 v[32:35], v2, s[8:11], s17 offen sc1
  s_branch DB_kz_ker_53
DS_kz_ker_54:
  buffer_store_dwordx2 v[0:1], off, s[8:11], s19 offset:64 sc1
  s_branch DB_kz_ker_55
HELP_kz_ker_1:
  s_and_b32 s35, s3, 3
  s_or_b32 s38, s2, s35
  s_cmp_lg_u32 s38, 0
  s_cbranch_scc1 NE_kz_ker_62
  s_memrealtime s[38:39]
  s_waitcnt lgkmcnt(0)
  s_and_b32 s38, s38, -16
  s_bitset1_b32 s39, 31
  v_mov_b32 v12, s38
  v_mov_b32 v13, s39
  buffer_store_dwordx2 v[12:13], off, s[20:23], 0 sc1
NE_kz_ker_62:
  v_bfe_u32 v5, v1, 4, 1
  v_lshlrev_b32 v5, 2, v5
  v_and_b32 v6, 7, v1
  v_xor_b32 v5, v5, v6
  v_lshlrev_b32 v5, 4, v5
  v_lshrrev_b32 v7, 3, v1
  v_mad_u32_u24 v5, v7, s34, v5
  v_xor_b32 v6, 32, v5
  s_lshl_b32 s36, s6, 7
  s_mul_i32 s37, s35, 0x6000
  s_add_u32 s36, s36, s37
  s_mul_i32 s37, s35, 0xc00
  s_cmp_eq_u32 s35, 1
  s_cselect_b32 s38, 10, 0
  v_mov_b32 v12, s38
  v_mov_b32 v13, 0
  v_mov_b32 v14, 0
  v_mov_b32 v15, 0
  s_min_u32 s38, s35, 2
  s_lshl_b32 s38, s38, 10
  s_add_u32 s38, s38, 155648
  v_lshlrev_b32 v7, 4, v1
  s_cmp_ge_u32 s35, 2
  s_cselect_b32 s39, 0x1f0, -1
  v_and_b32 v7, s39, v7
  v_add_u32 v7, s38, v7
  ds_write_b128 v7, v[12:15]
  s_getpc_b64 s[38:39]
PC_kz_ker_63:
  s_sub_u32 s38, s38, PC_kz_ker_63-kz_kernel
  s_subb_u32 s39, s39, 0
  s_lshl_b32 s40, s5, 2
  s_add_u32 s40, s40, s35
  s_lshl_b32 s40, s40, 9
  v_and_b32 v7, 7, v1
  v_lshlrev_b32 v7, 6, v7
  v_add_u32 v7, s40, v7
  v_min_u32 v7, kz_kernel_exit-kz_kernel, v7
  global_load_dword v31, v7, s[38:39]
  s_barrier
  s_sub_u32 s3, s3, 4
  s_load_dwordx2 s[24:25], s[0:1], 16
  s_mov_b32 s26, 0x80000
  s_mov_b32 s27, 0x00020000
  s_load_dwordx2 s[28:29], s[0:1], 40
  s_mov_b32 s30, 0x1c0000
  s_mov_b32 s31, 0x00020000
  s_xor_b32 s53, s52, 0
  s_mul_i32 s53, s53, 0x18000
  s_add_u32 s53, s53, s36
  s_add_u32 m0, s37, 0
  s_waitcnt lgkmcnt(0)
  buffer_load_dwordx4 v5, s[16:19], s53 offen lds
  buffer_load_dwordx4 v6, s[16:19], s53 offen offset:1024 lds
  buffer_load_dwordx4 v5, s[16:19], s53 offen offset:2048 lds
  s_xor_b32 s53, s52, 1
  s_mul_i32 s53, s53, 0x18000
  s_add_u32 s53, s53, s36
  s_add_u32 m0, s37, 12288
  s_nop 0
  buffer_load_dwordx4 v5, s[16:19], s53 offen lds
  buffer_load_dwordx4 v6, s[16:19], s53 offen offset:1024 lds
  buffer_load_dwordx4 v5, s[16:19], s53 offen offset:2048 lds
  s_xor_b32 s53, s52, 2
  s_mul_i32 s53, s53, 0x18000
  s_add_u32 s53, s53, s36
  s_add_u32 m0, s37, 24576
  s_nop 0
  buffer_load_dwordx4 v5, s[16:19], s53 offen lds
  buffer_load_dwordx4 v6, s[16:19], s53 offen offset:1024 lds
  buffer_load_dwordx4 v5, s[16:19], s53 offen offset:2048 lds
  s_xor_b32 s53, s52, 3
  s_mul_i32 s53, s53, 0x18000
  s_add_u32 s53, s53, s36
  s_add_u32 m0, s37, 36864
  s_nop 0
  buffer_load_dwordx4 v5, s[16:19], s53 offen lds
  buffer_load_dwordx4 v6, s[16:19], s53 offen offset:1024 lds
  buffer_load_dwordx4 v5, s[16:19], s53 offen offset:2048 lds
  s_xor_b32 s53, s52, 4
  s_mul_i32 s53, s53, 0x18000
  s_add_u32 s53, s53, s36
  s_add_u32 m0, s37, 49152
  s_nop 0
  buffer_load_dwordx4 v5, s[16:19], s53 offen lds
  buffer_load_dwordx4 v6, s[16:19], s53 offen offset:1024 lds
  buffer_load_dwordx4 v5, s[16:19], s53 offen offset:2048 lds
  v_lshlrev_b32 v2, 4, v1
  s_movk_i32 s38, 0x400
  v_bfe_u32 v20, v1, 4, 1
  v_lshlrev_b32 v20, 2, v20
  v_and_b32 v22, 7, v1
  v_xor_b32 v20, v20, v22
  v_lshlrev_b32 v20, 4, v20
  v_lshrrev_b32 v23, 3, v1
  v_mad_u32_u24 v20, v23, s38, v20
  v_add_u32 v21, 7168, v20
  s_lshl_b32 s40, s6, 7
  s_lshl_b32 s41, s3, 13
  s_add_u32 s40, s40, s41
  s_lshl_b32 s41, s3, 10
  s_waitcnt vmcnt(15)
  s_mov_b32 s54, s6
  s_lshl_b32 s55, s4, 2
  s_add_u32 s55, s55, s7
  v_lshrrev_b32 v3, 1, v1
  v_add_u32 v3, s54, v3
  v_and_b32 v3, 7, v3
  v_lshlrev_b32 v3, 10, v3
  v_and_b32 v4, 1, v1
  v_lshl_or_b32 v3, v4, 7, v3
  s_lshr_b32 s42, s55, 1
  s_lshl_b32 s42, s42, 13
  s_lshl_b32 s38, s3, 8
  s_add_u32 s42, s42, s38
  s_add_u32 s42, s42, 0x2000000
  s_lshl_b32 s46, s3, 11
  s_lshl_b32 s43, s55, 16
  s_add_u32 s43, s43, s46
  s_add_u32 s43, s43, 0x200000
  v_and_b32 v4, 3, v1
  v_lshlrev_b32 v4, 8, v4
  v_lshrrev_b32 v7, 2, v1
  v_lshl_add_u32 v4, v7, 2, v4
  v_add_u32 v4, 156672, v4
  s_lshr_b32 s47, s3, 1
  s_lshl_b32 s47, s47, 1
  s_mul_i32 s48, s3, 458752
  s_lshl_b32 s38, s6, 7
  s_add_u32 s48, s48, s38
  s_cmp_ge_u32 s7, 2
  s_cselect_b32 s38, 49152, 0
  s_cselect_b32 s39, 0xffff0000, 0
  s_add_u32 s49, s48, s39
  s_add_u32 s48, s48, s38
  v_and_b32 v7, 1, v1
  v_lshlrev_b32 v7, 1, v7
  v_bfe_u32 v27, v1, 1, 1
  v_or_b32 v27, v27, v7
  v_lshlrev_b32 v27, 3, v27
  v_bfe_u32 v7, v1, 3, 1
  v_lshl_or_b32 v27, v7, 6, v27
  v_bfe_u32 v7, v1, 2, 2
  v_lshl_or_b32 v27, v7, 7, v27
  v_lshrrev_b32 v7, 5, v1
  v_lshl_or_b32 v27, v7, 10, v27
  v_bfe_u32 v7, v1, 4, 1
  v_lshl_or_b32 v31, v7, 16, v27
  v_lshl_or_b32 v27, v7, 5, v27
  v_lshl_or_b32 v31, v7, 5, v31
  v_add_u32 v31, s46, v31
  s_add_u32 s38, s46, 32768
  v_add_u32 v27, s38, v27
  s_and_b32 s38, s3, 1
  s_lshl_b32 s38, s38, 6
  v_xor_b32 v27, s38, v27
  v_xor_b32 v28, 64, v27
  v_add_u32 v29, 0x10000, v27
  v_add_u32 v30, 0x10000, v28
  v_mov_b32 v32, -1
  v_mov_b32 v33, -1
  v_mov_b32 v34, -1
  v_mov_b32 v35, -1
  v_mov_b32 v26, 1
  v_and_b32 v37, 3, v1
  v_lshlrev_b32 v37, 8, v37
  v_add_u32 v37, 155652, v37
  s_waitcnt vmcnt(9)
  s_waitcnt lgkmcnt(0)
  s_barrier
  s_xor_b32 s53, s52, 5
  s_mul_i32 s53, s53, 0x18000
  s_add_u32 s53, s53, s36
  s_add_u32 m0, s37, 61440
  s_nop 0
  buffer_load_dwordx4 v5, s[16:19], s53 offen lds
  buffer_load_dwordx4 v6, s[16:19], s53 offen offset:1024 lds
  buffer_load_dwordx4 v5, s[16:19], s53 offen offset:2048 lds
  s_xor_b32 s53, s52, 6
  s_mul_i32 s53, s53, 0x18000
  s_add_u32 s53, s53, s36
  s_add_u32 m0, s37, 73728
  s_nop 0
  buffer_load_dwordx4 v5, s[16:19], s53 offen lds
  buffer_load_dwordx4 v6, s[16:19], s53 offen offset:1024 lds
  buffer_load_dwordx4 v5, s[16:19], s53 offen offset:2048 lds
  s_waitcnt vmcnt(12)
  s_barrier
  s_xor_b32 s53, s52, 7
  s_mul_i32 s53, s53, 0x18000
  s_add_u32 s53, s53, s36
  s_add_u32 m0, s37, 0
  s_nop 0
  buffer_load_dwordx4 v5, s[16:19], s53 offen lds
  buffer_load_dwordx4 v6, s[16:19], s53 offen offset:1024 lds
  buffer_load_dwordx4 v5, s[16:19], s53 offen offset:2048 lds
  s_waitcnt vmcnt(12)
  s_barrier
  s_xor_b32 s53, s52, 8
  s_mul_i32 s53, s53, 0x18000
  s_add_u32 s53, s53, s36
  s_add_u32 m0, s37, 12288
  s_nop 0
  buffer_load_dwordx4 v5, s[16:19], s53 offen lds
  buffer_load_dwordx4 v6, s[16:19], s53 offen offset:1024 lds
  buffer_load_dwordx4 v5, s[16:19], s53 offen offset:2048 lds
  s_waitcnt vmcnt(12)
  s_barrier
  s_xor_b32 s53, s52, 9
  s_mul_i32 s53, s53, 0x18000
  s_add_u32 s53, s53, s36
  s_add_u32 m0, s37, 24576
  s_nop 0
  buffer_load_dwordx4 v5, s[16:19], s53 offen lds
  buffer_load_dwordx4 v6, s[16:19], s53 offen offset:1024 lds
  buffer_load_dwordx4 v5, s[16:19], s53 offen offset:2048 lds
  s_waitcnt vmcnt(12)
  s_barrier
  s_xor_b32 s53, s52, 10
  s_mul_i32 s53, s53, 0x18000
  s_add_u32 s53, s53, s36
  s_add_u32 m0, s37, 36864
  s_nop 0
  buffer_load_dwordx4 v5, s[16:19], s53 offen lds
  buffer_load_dwordx4 v6, s[16:19], s53 offen offset:1024 lds
  buffer_load_dwordx4 v5, s[16:19], s53 offen offset:2048 lds
  s_waitcnt vmcnt(12)
  s_barrier
  s_xor_b32 s53, s52, 11
  s_mul_i32 s53, s53, 0x18000
  s_add_u32 s53, s53, s36
  s_add_u32 m0, s37, 49152
  s_nop 0
  buffer_load_dwordx4 v5, s[16:19], s53 offen lds
  buffer_load_dwordx4 v6, s[16:19], s53 offen offset:1024 lds
  buffer_load_dwordx4 v5, s[16:19], s53 offen offset:2048 lds
  s_waitcnt vmcnt(12)
  s_barrier
  s_xor_b32 s53, s52, 12
  s_mul_i32 s53, s53, 0x18000
  s_add_u32 s53, s53, s36
  s_add_u32 m0, s37, 61440
  s_nop 0
  buffer_load_dwordx4 v5, s[16:19], s53 offen lds
  buffer_load_dwordx4 v6, s[16:19], s53 offen offset:1024 lds
  buffer_load_dwordx4 v5, s[16:19], s53 offen offset:2048 lds
  s_waitcnt vmcnt(12)
  s_barrier
  s_xor_b32 s53, s52, 13
  s_mul_i32 s53, s53, 0x18000
  s_add_u32 s53, s53, s36
  s_add_u32 m0, s37, 73728
  s_nop 0
  buffer_load_dwordx4 v5, s[16:19], s53 offen lds
  buffer_load_dwordx4 v6, s[16:19], s53 offen offset:1024 lds
  buffer_load_dwordx4 v5, s[16:19], s53 offen offset:2048 lds
  s_waitcnt vmcnt(12)
  s_barrier
  s_xor_b32 s53, s52, 14
  s_mul_i32 s53, s53, 0x18000
  s_add_u32 s53, s53, s36
  s_add_u32 m0, s37, 0
  s_nop 0
  buffer_load_dwordx4 v5, s[16:19], s53 offen lds
  buffer_load_dwordx4 v6, s[16:19], s53 offen offset:1024 lds
  buffer_load_dwordx4 v5, s[16:19], s53 offen offset:2048 lds
  s_waitcnt vmcnt(12)
  s_barrier
  s_xor_b32 s53, s52, 15
  s_mul_i32 s53, s53, 0x18000
  s_add_u32 s53, s53, s36
  s_add_u32 m0, s37, 12288
  s_nop 0
  buffer_load_dwordx4 v5, s[16:19], s53 offen lds
  buffer_load_dwordx4 v6, s[16:19], s53 offen offset:1024 lds
  buffer_load_dwordx4 v5, s[16:19], s53 offen offset:2048 lds
  s_waitcnt vmcnt(12)
  s_waitcnt lgkmcnt(0)
  s_barrier
  s_add_u32 s38, s40, 0x0
  s_add_u32 m0, s41, 0x6000
  s_nop 0
  buffer_load_dwordx4 v20, s[24:27], s38 offen lds
  s_add_u32 s38, s40, 0x8000
  s_add_u32 m0, s41, 0x7000
  s_nop 0
  buffer_load_dwordx4 v20, s[24:27], s38 offen lds
  s_add_u32 s38, s40, 0x10000
  s_add_u32 m0, s41, 0x8000
  s_nop 0
  buffer_load_dwordx4 v20, s[24:27], s38 offen lds
  s_waitcnt vmcnt(12)
  s_barrier
  s_add_u32 s38, s40, 0x18000
  s_add_u32 m0, s41, 0x9000
  s_nop 0
  buffer_load_dwordx4 v20, s[24:27], s38 offen lds
  s_add_u32 s38, s40, 0x20000
  s_add_u32 m0, s41, 0xa000
  s_nop 0
  buffer_load_dwordx4 v20, s[24:27], s38 offen lds
  s_add_u32 s38, s40, 0x40000
  s_add_u32 m0, s41, 0xb000
  s_nop 0
  buffer_load_dwordx4 v20, s[24:27], s38 offen lds
  s_waitcnt vmcnt(12)
  s_barrier
  s_add_u32 s38, s40, 0x48000
  s_add_u32 m0, s41, 0xc000
  s_nop 0
  buffer_load_dwordx4 v20, s[24:27], s38 offen lds
  s_add_u32 s38, s40, 0x50000
  s_add_u32 m0, s41, 0xd000
  s_nop 0
  buffer_load_dwordx4 v20, s[24:27], s38 offen lds
  s_add_u32 s38, s40, 0x58000
  s_add_u32 m0, s41, 0xe000
  s_nop 0
  buffer_load_dwordx4 v20, s[24:27], s38 offen lds
  s_waitcnt vmcnt(12)
  s_barrier
  s_add_u32 s38, s40, 0x60000
  s_add_u32 m0, s41, 0xf000
  s_nop 0
  buffer_load_dwordx4 v20, s[24:27], s38 offen lds
  buffer_load_dwordx2 v[24:25], off, s[20:23], 0 sc1
  s_waitcnt vmcnt(11)
  s_barrier
  s_load_dwordx2 s[16:17], s[0:1], 48
  s_mov_b32 s18, 0x1c0000
  s_mov_b32 s19, 0x00020000
  s_load_dwordx2 s[12:13], s[0:1], 56
  s_mov_b32 s14, 0x200000
  s_mov_b32 s15, 0x00020000
  s_barrier
  s_waitcnt vmcnt(0)
  s_barrier
EL_kz_ker_64:
  s_waitcnt vmcnt(0)
  v_readfirstlane_b32 s56, v24
  v_readfirstlane_b32 s57, v25
  s_bitcmp1_b32 s57, 31
  s_cbranch_scc1 ED_kz_ker_65
  buffer_load_dwordx2 v[24:25], off, s[20:23], 0 sc1
  s_sub_u32 s60, s60, 1
  s_cbranch_scc0 EL_kz_ker_64
  s_mov_b32 s60, 0
ED_kz_ker_65:
  s_getreg_b32 s58, hwreg(HW_REG_XCC_ID)
  s_and_b32 s58, s58, 15
  s_add_u32 s58, s58, s56
  s_mov_b32 s59, s57
  s_load_dwordx2 s[20:21], s[0:1], 0
  s_mov_b32 s22, 0x200000
  s_mov_b32 s23, 0x00020000
  s_mov_b64 exec, 3
PL_kz_ker_66:
  s_waitcnt vmcnt(0)
  buffer_load_dwordx2 v[24:25], v3, s[8:11], s42 offen sc1
  s_waitcnt vmcnt(0)
  v_cmp_eq_u64 s[44:45], s[56:57], v[24:25]
  s_andn2_b64 s[62:63], 3, s[44:45]
  s_cmp_eq_u64 s[62:63], 0
  s_cbranch_scc1 PD_kz_ker_67
  s_sub_u32 s60, s60, 1
  s_cbranch_scc0 PL_kz_ker_66
  s_mov_b32 s60, 0
PD_kz_ker_67:
  s_mov_b64 exec, -1
  s_add_u32 s38, s54, 0
  s_and_b32 s38, s38, 7
  s_lshl_b32 s38, s38, 13
  s_add_u32 s38, s38, s43
  s_add_u32 m0, s46, 0
  s_nop 0
  buffer_load_dwordx4 v2, s[8:11], s38 offen sc1 lds
  buffer_load_dwordx4 v2, s[8:11], s38 offen offset:1024 sc1 lds
  s_add_u32 s38, s38, 0x200000
  s_add_u32 m0, s46, 65536
  s_nop 0
  buffer_load_dwordx4 v2, s[8:11], s38 offen sc1 lds
  buffer_load_dwordx4 v2, s[8:11], s38 offen offset:1024 sc1 lds
  s_sub_u32 s38, s38, 0x400000
  s_add_u32 m0, s46, 122880
  s_nop 0
  buffer_load_dwordx4 v2, s[8:11], s38 offen offset:0 sc1 lds
  buffer_load_dwordx4 v2, s[8:11], s38 offen offset:1024 sc1 lds
  buffer_load_dwordx2 v[24:25], v3, s[8:11], s42 offen sc1
  s_waitcnt vmcnt(1)
  s_barrier
  s_waitcnt vmcnt(0)
  v_cmp_eq_u64 s[44:45], s[56:57], v[24:25]
  s_andn2_b32 s38, 12, s44
  s_cbranch_scc1 RP_kz_ker_68
RB_kz_ker_69:
  s_add_u32 s38, s54, 1
  s_and_b32 s38, s38, 7
  s_lshl_b32 s38, s38, 13
  s_add_u32 s38, s38, s43
  s_add_u32 m0, s46, 8192
  s_nop 0
  buffer_load_dwordx4 v2, s[8:11], s38 offen sc1 lds
  buffer_load_dwordx4 v2, s[8:11], s38 offen offset:1024 sc1 lds
  s_add_u32 s38, s38, 0x200000
  s_add_u32 m0, s46, 73728
  s_nop 0
  buffer_load_dwordx4 v2, s[8:11], s38 offen sc1 lds
  buffer_load_dwordx4 v2, s[8:11], s38 offen offset:1024 sc1 lds
  s_waitcnt vmcnt(0)
  s_add_u32 s38, s47, 4
  v_lshlrev_b32 v7, s38, v26
  ds_add_u32 v4, v7
PG_kz_ker_70:
  ds_read_b32 v41, v37
  s_waitcnt lgkmcnt(0)
  v_cmp_le_u32 vcc, 0x1, v41
  s_cmp_eq_u64 vcc, -1
  s_cbranch_scc1 PGD_kz_ker_71
  s_sleep 2
  s_sub_u32 s60, s60, 1
  s_cbranch_scc0 PG_kz_ker_70
  s_mov_b32 s60, 0
PGD_kz_ker_71:
  s_andn2_b32 s38, 48, s44
  s_cbranch_scc1 RP_kz_ker_72
RB_kz_ker_73:
  s_add_u32 s38, s54, 2
  s_and_b32 s38, s38, 7
  s_lshl_b32 s38, s38, 13
  s_add_u32 s38, s38, s43
  s_add_u32 m0, s46, 16384
  s_nop 0
  buffer_load_dwordx4 v2, s[8:11], s38 offen sc1 lds
  buffer_load_dwordx4 v2, s[8:11], s38 offen offset:1024 sc1 lds
  s_add_u32 s38, s38, 0x200000
  s_add_u32 m0, s46, 81920
  s_nop 0
  buffer_load_dwordx4 v2, s[8:11], s38 offen sc1 lds
  buffer_load_dwordx4 v2, s[8:11], s38 offen offset:1024 sc1 lds
  s_andn2_b32 s38, 192, s44
  s_cbranch_scc1 RP_kz_ker_74
RB_kz_ker_75:
  s_add_u32 s38, s54, 3
  s_and_b32 s38, s38, 7
  s_lshl_b32 s38, s38, 13
  s_add_u32 s38, s38, s43
  s_add_u32 m0, s46, 24576
  s_nop 0
  buffer_load_dwordx4 v2, s[8:11], s38 offen sc1 lds
  buffer_load_dwordx4 v2, s[8:11], s38 offen offset:1024 sc1 lds
  s_add_u32 s38, s38, 0x200000
  s_add_u32 m0, s46, 90112
  s_nop 0
  buffer_load_dwordx4 v2, s[8:11], s38 offen sc1 lds
  buffer_load_dwordx4 v2, s[8:11], s38 offen offset:1024 sc1 lds
  s_waitcnt vmcnt(4)
  s_add_u32 s38, s47, 8
  v_lshlrev_b32 v7, s38, v26
  ds_add_u32 v4, v7
PG_kz_ker_76:
  ds_read_b32 v41, v37
  s_waitcnt lgkmcnt(0)
  v_cmp_le_u32 vcc, 0x1, v41
  s_cmp_eq_u64 vcc, -1
  s_cbranch_scc1 PGD_kz_ker_77
  s_sleep 2
  s_sub_u32 s60, s60, 1
  s_cbranch_scc0 PG_kz_ker_76
  s_mov_b32 s60, 0
PGD_kz_ker_77:
  s_add_u32 s38, s48, 0x0
  s_add_u32 m0, s46, 0x8000
  s_nop 0
  buffer_load_dwordx4 v20, s[16:19], s38 offen lds
  buffer_load_dwordx4 v21, s[16:19], s38 offen offset:1024 lds
  s_add_u32 s38, s48, 0x1c000
  s_add_u32 m0, s46, 0x18000
  s_nop 0
  buffer_load_dwordx4 v20, s[16:19], s38 offen lds
  buffer_load_dwordx4 v21, s[16:19], s38 offen offset:1024 lds
  s_add_u32 s38, s48, 0x38000
  s_add_u32 m0, s46, 0xa000
  s_nop 0
  buffer_load_dwordx4 v20, s[16:19], s38 offen lds
  buffer_load_dwordx4 v21, s[16:19], s38 offen offset:1024 lds
  s_add_u32 s38, s48, 0x54000
  s_add_u32 m0, s46, 0x1a000
  s_nop 0
  buffer_load_dwordx4 v20, s[16:19], s38 offen lds
  buffer_load_dwordx4 v21, s[16:19], s38 offen offset:1024 lds
  s_add_u32 s38, s48, 0x4000
  s_add_u32 m0, s46, 0xc000
  s_nop 0
  buffer_load_dwordx4 v20, s[16:19], s38 offen lds
  buffer_load_dwordx4 v21, s[16:19], s38 offen offset:1024 lds
  s_add_u32 s38, s48, 0x20000
  s_add_u32 m0, s46, 0x1c000
  s_nop 0
  buffer_load_dwordx4 v20, s[16:19], s38 offen lds
  buffer_load_dwordx4 v21, s[16:19], s38 offen offset:1024 lds
  s_add_u32 s38, s48, 0x3c000
  s_add_u32 m0, s46, 0xe000
  s_nop 0
  buffer_load_dwordx4 v20, s[16:19], s38 offen lds
  buffer_load_dwordx4 v21, s[16:19], s38 offen offset:1024 lds
  s_add_u32 s38, s48, 0x58000
  s_add_u32 m0, s46, 0x1e000
  s_nop 0
  buffer_load_dwordx4 v20, s[16:19], s38 offen lds
  buffer_load_dwordx4 v21, s[16:19], s38 offen offset:1024 lds
  s_lshl_b32 s38, s54, 2
  s_add_u32 s38, s38, s3
  s_lshl_b32 s50, s38, 9
  s_lshl_b32 s38, s38, 6
  s_add_u32 s38, s38, s55
  s_lshl_b32 s38, s38, 10
  s_add_u32 s38, s38, 0xc00000
  buffer_store_dwordx4 v[32:35], v2, s[8:11], s38 offen sc1
  s_add_u32 s38, s38, 0x8000
  buffer_store_dwordx4 v[32:35], v2, s[8:11], s38 offen sc1
  s_lshl_b32 s38, s55, 3
  s_add_u32 s50, s50, s38
  s_add_u32 s50, s50, 0x2024000
  s_waitcnt vmcnt(18)
  s_add_u32 s38, s47, 12
  v_lshlrev_b32 v7, s38, v26
  ds_add_u32 v4, v7
  s_waitcnt vmcnt(16)
  ds_read_b64_tr_b16 v[88:89], v27 offset:0
  ds_read_b64_tr_b16 v[90:91], v27 offset:512
  ds_read_b64_tr_b16 v[92:93], v28 offset:0
  ds_read_b64_tr_b16 v[94:95], v28 offset:512
  s_waitcnt lgkmcnt(0)
  s_waitcnt vmcnt(14)
  ds_read_b64_tr_b16 v[96:97], v29 offset:0
  ds_read_b64_tr_b16 v[98:99], v29 offset:512
  ds_read_b64_tr_b16 v[100:101], v30 offset:0
  ds_read_b64_tr_b16 v[102:103], v30 offset:512
  s_waitcnt lgkmcnt(0)
  s_andn2_b32 s38, 768, s44
  s_cbranch_scc1 RP_kz_ker_78
RB_kz_ker_79:
  s_add_u32 s38, s54, 4
  s_and_b32 s38, s38, 7
  s_lshl_b32 s38, s38, 13
  s_add_u32 s38, s38, s43
  s_add_u32 m0, s46, 32768
  s_nop 0
  buffer_load_dwordx4 v2, s[8:11], s38 offen sc1 lds
  buffer_load_dwordx4 v2, s[8:11], s38 offen offset:1024 sc1 lds
  s_add_u32 s38, s38, 0x200000
  s_add_u32 m0, s46, 98304
  s_nop 0
  buffer_load_dwordx4 v2, s[8:11], s38 offen sc1 lds
  buffer_load_dwordx4 v2, s[8:11], s38 offen offset:1024 sc1 lds
  s_waitcnt vmcnt(16)
  ds_read_b64_tr_b16 v[104:105], v27 offset:8192
  ds_read_b64_tr_b16 v[106:107], v27 offset:8704
  ds_read_b64_tr_b16 v[108:109], v28 offset:8192
  ds_read_b64_tr_b16 v[110:111], v28 offset:8704
  s_waitcnt lgkmcnt(0)
  s_waitcnt vmcnt(14)
  ds_read_b64_tr_b16 v[112:113], v29 offset:8192
  ds_read_b64_tr_b16 v[114:115], v29 offset:8704
  ds_read_b64_tr_b16 v[116:117], v30 offset:8192
  ds_read_b64_tr_b16 v[118:119], v30 offset:8704
  s_waitcnt lgkmcnt(0)
  s_andn2_b32 s38, 3072, s44
  s_cbranch_scc1 RP_kz_ker_80
RB_kz_ker_81:
  s_add_u32 s38, s54, 5
  s_and_b32 s38, s38, 7
  s_lshl_b32 s38, s38, 13
  s_add_u32 s38, s38, s43
  s_add_u32 m0, s46, 40960
  s_nop 0
  buffer_load_dwordx4 v2, s[8:11], s38 offen sc1 lds
  buffer_load_dwordx4 v2, s[8:11], s38 offen offset:1024 sc1 lds
  s_add_u32 s38, s38, 0x200000
  s_add_u32 m0, s46, 106496
  s_nop 0
  buffer_load_dwordx4 v2, s[8:11], s38 offen sc1 lds
  buffer_load_dwordx4 v2, s[8:11], s38 offen offset:1024 sc1 lds
  s_waitcnt vmcnt(16)
  ds_read_b64_tr_b16 v[120:121], v27 offset:16384
  ds_read_b64_tr_b16 v[122:123], v27 offset:16896
  ds_read_b64_tr_b16 v[124:125], v28 offset:16384
  ds_read_b64_tr_b16 v[126:127], v28 offset:16896
  s_waitcnt lgkmcnt(0)
  s_add_u32 s38, s48, 0x8000
  s_add_u32 m0, s46, 0xc000
  s_nop 0
  buffer_load_dwordx4 v20, s[16:19], s38 offen lds
  buffer_load_dwordx4 v21, s[16:19], s38 offen offset:1024 lds
  s_waitcnt vmcnt(16)
  ds_read_b64_tr_b16 v[128:129], v29 offset:16384
  ds_read_b64_tr_b16 v[130:131], v29 offset:16896
  ds_read_b64_tr_b16 v[132:133], v30 offset:16384
  ds_read_b64_tr_b16 v[134:135], v30 offset:16896
  s_waitcnt lgkmcnt(0)
  s_add_u32 s38, s48, 0x24000
  s_add_u32 m0, s46, 0x1c000
  s_nop 0
  buffer_load_dwordx4 v20, s[16:19], s38 offen lds
  buffer_load_dwordx4 v21, s[16:19], s38 offen offset:1024 lds
  s_waitcnt vmcnt(16)
  ds_read_b64_tr_b16 v[136:137], v27 offset:24576
  ds_read_b64_tr_b16 v[138:139], v27 offset:25088
  ds_read_b64_tr_b16 v[140:141], v28 offset:24576
  ds_read_b64_tr_b16 v[142:143], v28 offset:25088
  s_waitcnt lgkmcnt(0)
  s_add_u32 s38, s48, 0x40000
  s_add_u32 m0, s46, 0xe000
  s_nop 0
  buffer_load_dwordx4 v20, s[16:19], s38 offen lds
  buffer_load_dwordx4 v21, s[16:19], s38 offen offset:1024 lds
  s_waitcnt vmcnt(16)
  ds_read_b64_tr_b16 v[144:145], v29 offset:24576
  ds_read_b64_tr_b16 v[146:147], v29 offset:25088
  ds_read_b64_tr_b16 v[148:149], v30 offset:24576
  ds_read_b64_tr_b16 v[150:151], v30 offset:25088
  s_waitcnt lgkmcnt(0)
  s_add_u32 s38, s48, 0x5c000
  s_add_u32 m0, s46, 0x1e000
  s_nop 0
  buffer_load_dwordx4 v20, s[16:19], s38 offen lds
  buffer_load_dwordx4 v21, s[16:19], s38 offen offset:1024 lds
  s_waitcnt vmcnt(6)
  ds_read_b64_tr_b16 v[152:153], v27 offset:16384
  ds_read_b64_tr_b16 v[154:155], v27 offset:16896
  ds_read_b64_tr_b16 v[156:157], v28 offset:16384
  ds_read_b64_tr_b16 v[158:159], v28 offset:16896
  s_waitcnt vmcnt(12)
  s_add_u32 s38, s47, 16
  v_lshlrev_b32 v7, s38, v26
  ds_add_u32 v4, v7
  s_waitcnt vmcnt(8)
  s_add_u32 s38, s47, 20
  v_lshlrev_b32 v7, s38, v26
  ds_add_u32 v4, v7
  s_waitcnt lgkmcnt(0)
  s_add_u32 s38, s48, 0xc000
  s_add_u32 m0, s46, 0xc000
  s_nop 0
  buffer_load_dwordx4 v20, s[16:19], s38 offen lds
  buffer_load_dwordx4 v21, s[16:19], s38 offen offset:1024 lds
  s_waitcnt vmcnt(18)
  v_mov_b32 v24, s58
  v_mov_b32 v25, s59
  buffer_store_dwordx2 v[24:25], off, s[8:11], s50 sc1
  s_lshl_b32 s38, s4, 2
  s_add_u32 s38, s38, s3
  s_lshl_b32 s38, s38, 6
  s_add_u32 s38, s38, s5
  s_lshl_b32 s38, s38, 3
  s_add_u32 s38, s38, 0x2024100
  buffer_store_dwordx2 v[24:25], off, s[8:11], s38 sc1
  s_movk_i32 s38, 0xe00
  v_bfe_u32 v32, v1, 4, 1
  v_lshlrev_b32 v32, 2, v32
  v_and_b32 v34, 7, v1
  v_xor_b32 v32, v32, v34
  v_lshlrev_b32 v32, 4, v32
  v_lshrrev_b32 v35, 3, v1
  v_mad_u32_u24 v32, v35, s38, v32
  v_add_u32 v33, 27648, v32
  v_xor_b32 v34, 32, v32
  v_add_u32 v35, 27648, v34
  s_lshr_b32 s51, s5, 1
  s_mul_i32 s51, s51, 224
  s_and_b32 s39, s5, 1
  s_mul_i32 s39, s39, 96
  s_add_u32 s51, s51, s39
  s_mul_i32 s39, s3, 57344
  s_add_u32 s51, s51, s39
  v_lshrrev_b32 v36, 1, v1
  v_mul_u32_u24 v36, s38, v36
  v_and_b32 v41, 1, v1
  v_lshl_add_u32 v36, v41, 6, v36
  v_xor_b32 v38, 32, v31
  v_xor_b32 v39, 64, v31
  v_xor_b32 v40, 96, v31
  v_bfe_u32 v41, v1, 3, 2
  v_mov_b32 v42, 0x3f803f80
  v_cmp_eq_u32 vcc, 0, v41
  s_nop 1
  v_cndmask_b32 v64, 0, v42, vcc
  v_mov_b32 v65, v64
  v_mov_b32 v66, v64
  v_mov_b32 v67, v64
  v_cmp_eq_u32 vcc, 1, v41
  s_nop 1
  v_cndmask_b32 v68, 0, v42, vcc
  v_mov_b32 v69, v68
  v_mov_b32 v70, v68
  v_mov_b32 v71, v68
  v_cmp_eq_u32 vcc, 2, v41
  s_nop 1
  v_cndmask_b32 v72, 0, v42, vcc
  v_mov_b32 v73, v72
  v_mov_b32 v74, v72
  v_mov_b32 v75, v72
  v_cmp_eq_u32 vcc, 3, v41
  s_nop 1
  v_cndmask_b32 v76, 0, v42, vcc
  v_mov_b32 v77, v76
  v_mov_b32 v78, v76
  v_mov_b32 v79, v76
  s_lshl_b32 s38, s3, 2
  s_add_u32 s38, s38, 157696
  v_and_b32 v42, 0x1f0, v2
  v_add_u32 v42, s38, v42
  v_add_u32 v47, s46, v2
  v_add_u32 v84, 0x10000, v47
  s_waitcnt vmcnt(8)
  ds_read_b64_tr_b16 v[160:161], v29 offset:16384
  ds_read_b64_tr_b16 v[162:163], v29 offset:16896
  ds_read_b64_tr_b16 v[164:165], v30 offset:16384
  ds_read_b64_tr_b16 v[166:167], v30 offset:16896
  s_waitcnt lgkmcnt(0)
  s_add_u32 s38, s48, 0x28000
  s_add_u32 m0, s46, 0x1c000
  s_nop 0
  buffer_load_dwordx4 v20, s[16:19], s38 offen lds
  buffer_load_dwordx4 v21, s[16:19], s38 offen offset:1024 lds
  s_waitcnt vmcnt(8)
  ds_read_b64_tr_b16 v[168:169], v27 offset:24576
  ds_read_b64_tr_b16 v[170:171], v27 offset:25088
  ds_read_b64_tr_b16 v[172:173], v28 offset:24576
  ds_read_b64_tr_b16 v[174:175], v28 offset:25088
  s_waitcnt lgkmcnt(0)
  s_add_u32 s38, s48, 0x44000
  s_add_u32 m0, s46, 0xe000
  s_nop 0
  buffer_load_dwordx4 v20, s[16:19], s38 offen lds
  buffer_load_dwordx4 v21, s[16:19], s38 offen offset:1024 lds
  s_waitcnt vmcnt(8)
  ds_read_b64_tr_b16 v[176:177], v29 offset:24576
  ds_read_b64_tr_b16 v[178:179], v29 offset:25088
  ds_read_b64_tr_b16 v[180:181], v30 offset:24576
  ds_read_b64_tr_b16 v[182:183], v30 offset:25088
  s_waitcnt lgkmcnt(0)
  s_add_u32 s38, s48, 0x60000
  s_add_u32 m0, s46, 0x1e000
  s_nop 0
  buffer_load_dwordx4 v20, s[16:19], s38 offen lds
  buffer_load_dwordx4 v21, s[16:19], s38 offen offset:1024 lds
  s_waitcnt vmcnt(8)
  ds_read_b64_tr_b16 v[184:185], v27 offset:16384
  ds_read_b64_tr_b16 v[186:187], v27 offset:16896
  ds_read_b64_tr_b16 v[188:189], v28 offset:16384
  ds_read_b64_tr_b16 v[190:191], v28 offset:16896
  s_waitcnt lgkmcnt(0)
  s_add_u32 s38, s49, 0x10000
  s_add_u32 m0, s46, 0xc000
  s_nop 0
  buffer_load_dwordx4 v20, s[16:19], s38 offen lds
  buffer_load_dwordx4 v21, s[16:19], s38 offen offset:1024 lds
  s_waitcnt vmcnt(6)
  ds_read_b64_tr_b16 v[192:193], v29 offset:16384
  ds_read_b64_tr_b16 v[194:195], v29 offset:16896
  ds_read_b64_tr_b16 v[196:197], v30 offset:16384
  ds_read_b64_tr_b16 v[198:199], v30 offset:16896
  s_waitcnt lgkmcnt(0)
  s_add_u32 s38, s49, 0x2c000
  s_add_u32 m0, s46, 0x1c000
  s_nop 0
  buffer_load_dwordx4 v20, s[16:19], s38 offen lds
  buffer_load_dwordx4 v21, s[16:19], s38 offen offset:1024 lds
  s_waitcnt vmcnt(6)
  ds_read_b64_tr_b16 v[200:201], v27 offset:24576
  ds_read_b64_tr_b16 v[202:203], v27 offset:25088
  ds_read_b64_tr_b16 v[204:205], v28 offset:24576
  ds_read_b64_tr_b16 v[206:207], v28 offset:25088
  s_waitcnt lgkmcnt(0)
  s_add_u32 s38, s49, 0x48000
  s_add_u32 m0, s46, 0xe000
  s_nop 0
  buffer_load_dwordx4 v20, s[16:19], s38 offen lds
  buffer_load_dwordx4 v21, s[16:19], s38 offen offset:1024 lds
  s_waitcnt vmcnt(6)
  ds_read_b64_tr_b16 v[208:209], v29 offset:24576
  ds_read_b64_tr_b16 v[210:211], v29 offset:25088
  ds_read_b64_tr_b16 v[212:213], v30 offset:24576
  ds_read_b64_tr_b16 v[214:215], v30 offset:25088
  s_waitcnt lgkmcnt(0)
  s_add_u32 s38, s49, 0x64000
  s_add_u32 m0, s46, 0x1e000
  s_nop 0
  buffer_load_dwordx4 v20, s[16:19], s38 offen lds
  buffer_load_dwordx4 v21, s[16:19], s38 offen offset:1024 lds
  s_waitcnt vmcnt(6)
  ds_read_b64_tr_b16 v[216:217], v27 offset:16384
  ds_read_b64_tr_b16 v[218:219], v27 offset:16896
  ds_read_b64_tr_b16 v[220:221], v28 offset:16384
  ds_read_b64_tr_b16 v[222:223], v28 offset:16896
  s_waitcnt lgkmcnt(0)
  s_add_u32 s38, s49, 0x14000
  s_add_u32 m0, s46, 0xc000
  s_nop 0
  buffer_load_dwordx4 v20, s[16:19], s38 offen lds
  buffer_load_dwordx4 v21, s[16:19], s38 offen offset:1024 lds
  s_waitcnt vmcnt(6)
  ds_read_b64_tr_b16 v[224:225], v29 offset:16384
  ds_read_b64_tr_b16 v[226:227], v29 offset:16896
  ds_read_b64_tr_b16 v[228:229], v30 offset:16384
  ds_read_b64_tr_b16 v[230:231], v30 offset:16896
  s_waitcnt vmcnt(4)
  ds_read_b64_tr_b16 v[232:233], v27 offset:24576
  ds_read_b64_tr_b16 v[234:235], v27 offset:25088
  ds_read_b64_tr_b16 v[236:237], v28 offset:24576
  ds_read_b64_tr_b16 v[238:239], v28 offset:25088
  s_waitcnt vmcnt(2)
  ds_read_b64_tr_b16 v[240:241], v29 offset:24576
  ds_read_b64_tr_b16 v[242:243], v29 offset:25088
  ds_read_b64_tr_b16 v[244:245], v30 offset:24576
  ds_read_b64_tr_b16 v[246:247], v30 offset:25088
  s_waitcnt vmcnt(0)
  ds_read_b64_tr_b16 v[248:249], v27 offset:16384
  ds_read_b64_tr_b16 v[250:251], v27 offset:16896
  ds_read_b64_tr_b16 v[252:253], v28 offset:16384
  ds_read_b64_tr_b16 v[254:255], v28 offset:16896
  s_waitcnt lgkmcnt(0)
  s_andn2_b32 s38, 12288, s44
  s_cbranch_scc1 RP_kz_ker_82
RB_kz_ker_83:
  s_add_u32 s38, s54, 6
  s_and_b32 s38, s38, 7
  s_lshl_b32 s38, s38, 13
  s_add_u32 s38, s38, s43
  s_add_u32 m0, s46, 49152
  s_nop 0
  buffer_load_dwordx4 v2, s[8:11], s38 offen sc1 lds
  buffer_load_dwordx4 v2, s[8:11], s38 offen offset:1024 sc1 lds
  s_add_u32 s38, s38, 0x200000
  s_add_u32 m0, s46, 114688
  s_nop 0
  buffer_load_dwordx4 v2, s[8:11], s38 offen sc1 lds
  buffer_load_dwordx4 v2, s[8:11], s38 offen offset:1024 sc1 lds
  s_andn2_b32 s38, 49152, s44
  s_cbranch_scc1 RP_kz_ker_84
RB_kz_ker_85:
  s_add_u32 s38, s54, 7
  s_and_b32 s38, s38, 7
  s_lshl_b32 s38, s38, 13
  s_add_u32 s38, s38, s43
  s_add_u32 m0, s46, 57344
  s_nop 0
  buffer_load_dwordx4 v2, s[8:11], s38 offen sc1 lds
  buffer_load_dwordx4 v2, s[8:11], s38 offen offset:1024 sc1 lds
  s_add_u32 s38, s38, 0x200000
  s_add_u32 m0, s46, 122880
  s_nop 0
  buffer_load_dwordx4 v2, s[8:11], s38 offen sc1 lds
  buffer_load_dwordx4 v2, s[8:11], s38 offen offset:1024 sc1 lds
  s_add_u32 s38, s40, 0x28000
  s_add_u32 m0, s41, 0x20000
  s_nop 0
  buffer_load_dwordx4 v20, s[24:27], s38 offen lds
  s_add_u32 s38, s40, 0x30000
  s_add_u32 m0, s41, 0x21000
  s_nop 0
  buffer_load_dwordx4 v20, s[24:27], s38 offen lds
  s_add_u32 s38, s40, 0x38000
  s_add_u32 m0, s41, 0x22000
  s_nop 0
  buffer_load_dwordx4 v20, s[24:27], s38 offen lds
  s_add_u32 s38, s40, 0x68000
  s_add_u32 m0, s41, 0x23000
  s_nop 0
  buffer_load_dwordx4 v20, s[24:27], s38 offen lds
  s_add_u32 s38, s40, 0x70000
  s_add_u32 m0, s41, 0x24000
  s_nop 0
  buffer_load_dwordx4 v20, s[24:27], s38 offen lds
  s_add_u32 s38, s40, 0x78000
  s_add_u32 m0, s41, 0x25000
  s_nop 0
  buffer_load_dwordx4 v20, s[24:27], s38 offen lds
  s_load_dwordx2 s[24:25], s[0:1], 32
  s_mov_b32 s26, 0x1c0000
  s_mov_b32 s27, 0x00020000
PG_kz_ker_86:
  ds_read_b32 v41, v37
  s_waitcnt lgkmcnt(0)
  v_cmp_le_u32 vcc, 0x1001, v41
  s_cmp_eq_u64 vcc, -1
  s_cbranch_scc1 PGD_kz_ker_87
  s_sleep 2
  s_sub_u32 s60, s60, 1
  s_cbranch_scc0 PG_kz_ker_86
  s_mov_b32 s60, 0
PGD_kz_ker_87:
  s_add_u32 m0, s46, 0
  s_nop 0
  buffer_load_dwordx4 v32, s[24:27], s51 offen lds
  buffer_load_dwordx4 v33, s[24:27], s51 offen offset:1024 lds
  s_add_u32 m0, s46, 65536
  s_nop 0
  buffer_load_dwordx4 v34, s[28:31], s51 offen lds
  buffer_load_dwordx4 v35, s[28:31], s51 offen offset:1024 lds
  s_add_u32 s51, s51, 229376
PG_kz_ker_88:
  ds_read_b32 v41, v37
  s_waitcnt lgkmcnt(0)
  v_cmp_le_u32 vcc, 0x3001, v41
  s_cmp_eq_u64 vcc, -1
  s_cbranch_scc1 PGD_kz_ker_89
  s_sleep 2
  s_sub_u32 s60, s60, 1
  s_cbranch_scc0 PG_kz_ker_88
  s_mov_b32 s60, 0
PGD_kz_ker_89:
  s_add_u32 m0, s46, 8192
  s_nop 0
  buffer_load_dwordx4 v32, s[24:27], s51 offen lds
  buffer_load_dwordx4 v33, s[24:27], s51 offen offset:1024 lds
  s_add_u32 m0, s46, 73728
  s_nop 0
  buffer_load_dwordx4 v34, s[28:31], s51 offen lds
  buffer_load_dwordx4 v35, s[28:31], s51 offen offset:1024 lds
  s_add_u32 s51, s51, 229376
  s_waitcnt vmcnt(18)
  s_add_u32 s38, s47, 24
  v_lshlrev_b32 v7, s38, v26
  ds_add_u32 v4, v7
  s_waitcnt vmcnt(14)
  s_add_u32 s38, s47, 28
  v_lshlrev_b32 v7, s38, v26
  ds_add_u32 v4, v7
PG_kz_ker_90:
  ds_read_b32 v41, v37
  s_waitcnt lgkmcnt(0)
  v_cmp_le_u32 vcc, 0x5001, v41
  s_cmp_eq_u64 vcc, -1
  s_cbranch_scc1 PGD_kz_ker_91
  s_sleep 2
  s_sub_u32 s60, s60, 1
  s_cbranch_scc0 PG_kz_ker_90
  s_mov_b32 s60, 0
PGD_kz_ker_91:
  s_add_u32 m0, s46, 16384
  s_nop 0
  buffer_load_dwordx4 v32, s[24:27], s51 offen lds
  buffer_load_dwordx4 v33, s[24:27], s51 offen offset:1024 lds
  s_add_u32 m0, s46, 81920
  s_nop 0
  buffer_load_dwordx4 v34, s[28:31], s51 offen lds
  buffer_load_dwordx4 v35, s[28:31], s51 offen offset:1024 lds
  s_add_u32 s51, s51, 229376
PG_kz_ker_92:
  ds_read_b32 v41, v37
  s_waitcnt lgkmcnt(0)
  v_cmp_le_u32 vcc, 0x7001, v41
  s_cmp_eq_u64 vcc, -1
  s_cbranch_scc1 PGD_kz_ker_93
  s_sleep 2
  s_sub_u32 s60, s60, 1
  s_cbranch_scc0 PG_kz_ker_92
  s_mov_b32 s60, 0
PGD_kz_ker_93:
  s_add_u32 m0, s46, 24576
  s_nop 0
  buffer_load_dwordx4 v32, s[24:27], s51 offen lds
  buffer_load_dwordx4 v33, s[24:27], s51 offen offset:1024 lds
  s_add_u32 m0, s46, 90112
  s_nop 0
  buffer_load_dwordx4 v34, s[28:31], s51 offen lds
  buffer_load_dwordx4 v35, s[28:31], s51 offen offset:1024 lds
  s_add_u32 s51, s51, 229376
  s_min_u32 s38, s5, 27
  s_lshl_b32 s38, s38, 7
  s_mul_i32 s39, s3, 229376
  s_add_u32 s38, s38, s39
  s_add_u32 s38, s38, 917504
  buffer_load_dword v43, v36, s[24:27], s38 offen
  buffer_load_dword v44, v36, s[28:31], s38 offen
  s_add_u32 s38, s38, 114688
  buffer_load_dword v45, v36, s[24:27], s38 offen
  buffer_load_dword v46, v36, s[28:31], s38 offen
  s_waitcnt vmcnt(16)
  ds_read_b64_tr_b16 v[8:9], v31 offset:0
  ds_read_b64_tr_b16 v[10:11], v31 offset:512
  ds_read_b64_tr_b16 v[12:13], v38 offset:0
  ds_read_b64_tr_b16 v[14:15], v38 offset:512
  ds_read_b64_tr_b16 v[16:17], v39 offset:0
  ds_read_b64_tr_b16 v[18:19], v39 offset:512
  ds_read_b64_tr_b16 v[80:81], v40 offset:0
  ds_read_b64_tr_b16 v[82:83], v40 offset:512
  s_waitcnt lgkmcnt(6)
  v_mfma_f32_32x32x16_bf16 v[48:63], v[64:67], v[8:11], 0
  s_waitcnt lgkmcnt(4)
  v_mfma_f32_32x32x16_bf16 v[48:63], v[68:71], v[12:15], v[48:63]
  s_waitcnt lgkmcnt(2)
  v_mfma_f32_32x32x16_bf16 v[48:63], v[72:75], v[16:19], v[48:63]
  s_waitcnt lgkmcnt(0)
  v_mfma_f32_32x32x16_bf16 v[48:63], v[76:79], v[80:83], v[48:63]
  ds_write_b128 v47, v[8:11] offset:0
  ds_write_b128 v47, v[12:15] offset:1024
  ds_write_b128 v84, v[16:19] offset:0
  ds_write_b128 v84, v[80:83] offset:1024
  s_waitcnt vmcnt(12)
  ds_read_b64_tr_b16 v[8:9], v31 offset:8192
  ds_read_b64_tr_b16 v[10:11], v31 offset:8704
  ds_read_b64_tr_b16 v[12:13], v38 offset:8192
  ds_read_b64_tr_b16 v[14:15], v38 offset:8704
  ds_read_b64_tr_b16 v[16:17], v39 offset:8192
  ds_read_b64_tr_b16 v[18:19], v39 offset:8704
  ds_read_b64_tr_b16 v[80:81], v40 offset:8192
  ds_read_b64_tr_b16 v[82:83], v40 offset:8704
  s_waitcnt lgkmcnt(6)
  v_mfma_f32_32x32x16_bf16 v[48:63], v[64:67], v[8:11], v[48:63]
  s_waitcnt lgkmcnt(4)
  v_mfma_f32_32x32x16_bf16 v[48:63], v[68:71], v[12:15], v[48:63]
  s_waitcnt lgkmcnt(2)
  v_mfma_f32_32x32x16_bf16 v[48:63], v[72:75], v[16:19], v[48:63]
  s_waitcnt lgkmcnt(0)
  v_mfma_f32_32x32x16_bf16 v[48:63], v[76:79], v[80:83], v[48:63]
  ds_write_b128 v47, v[8:11] offset:8192
  ds_write_b128 v47, v[12:15] offset:9216
  ds_write_b128 v84, v[16:19] offset:8192
  ds_write_b128 v84, v[80:83] offset:9216
  s_waitcnt vmcnt(8)
  ds_read_b64_tr_b16 v[8:9], v31 offset:16384
  ds_read_b64_tr_b16 v[10:11], v31 offset:16896
  ds_read_b64_tr_b16 v[12:13], v38 offset:16384
  ds_read_b64_tr_b16 v[14:15], v38 offset:16896
  ds_read_b64_tr_b16 v[16:17], v39 offset:16384
  ds_read_b64_tr_b16 v[18:19], v39 offset:16896
  ds_read_b64_tr_b16 v[80:81], v40 offset:16384
  ds_read_b64_tr_b16 v[82:83], v40 offset:16896
  s_waitcnt lgkmcnt(6)
  v_mfma_f32_32x32x16_bf16 v[48:63], v[64:67], v[8:11], v[48:63]
  s_waitcnt lgkmcnt(4)
  v_mfma_f32_32x32x16_bf16 v[48:63], v[68:71], v[12:15], v[48:63]
  s_waitcnt lgkmcnt(2)
  v_mfma_f32_32x32x16_bf16 v[48:63], v[72:75], v[16:19], v[48:63]
  s_waitcnt lgkmcnt(0)
  v_mfma_f32_32x32x16_bf16 v[48:63], v[76:79], v[80:83], v[48:63]
  ds_write_b128 v47, v[8:11] offset:16384
  ds_write_b128 v47, v[12:15] offset:17408
  ds_write_b128 v84, v[16:19] offset:16384
  ds_write_b128 v84, v[80:83] offset:17408
PG_kz_ker_94:
  ds_read_b32 v41, v37
  s_waitcnt lgkmcnt(0)
  v_cmp_le_u32 vcc, 0x9001, v41
  s_cmp_eq_u64 vcc, -1
  s_cbranch_scc1 PGD_kz_ker_95
  s_sleep 2
  s_sub_u32 s60, s60, 1
  s_cbranch_scc0 PG_kz_ker_94
  s_mov_b32 s60, 0
PGD_kz_ker_95:
  s_add_u32 m0, s46, 32768
  s_nop 0
  buffer_load_dwordx4 v32, s[24:27], s51 offen lds
  buffer_load_dwordx4 v33, s[24:27], s51 offen offset:1024 lds
  s_add_u32 m0, s46, 98304
  s_nop 0
  buffer_load_dwordx4 v34, s[28:31], s51 offen lds
  buffer_load_dwordx4 v35, s[28:31], s51 offen offset:1024 lds
  s_add_u32 s51, s51, 229376
  s_waitcnt vmcnt(8)
  ds_read_b64_tr_b16 v[8:9], v31 offset:24576
  ds_read_b64_tr_b16 v[10:11], v31 offset:25088
  ds_read_b64_tr_b16 v[12:13], v38 offset:24576
  ds_read_b64_tr_b16 v[14:15], v38 offset:25088
  ds_read_b64_tr_b16 v[16:17], v39 offset:24576
  ds_read_b64_tr_b16 v[18:19], v39 offset:25088
  ds_read_b64_tr_b16 v[80:81], v40 offset:24576
  ds_read_b64_tr_b16 v[82:83], v40 offset:25088
  s_waitcnt lgkmcnt(6)
  v_mfma_f32_32x32x16_bf16 v[48:63], v[64:67], v[8:11], v[48:63]
  s_waitcnt lgkmcnt(4)
  v_mfma_f32_32x32x16_bf16 v[48:63], v[68:71], v[12:15], v[48:63]
  s_waitcnt lgkmcnt(2)
  v_mfma_f32_32x32x16_bf16 v[48:63], v[72:75], v[16:19], v[48:63]
  s_waitcnt lgkmcnt(0)
  v_mfma_f32_32x32x16_bf16 v[48:63], v[76:79], v[80:83], v[48:63]
  ds_write_b128 v47, v[8:11] offset:24576
  ds_write_b128 v47, v[12:15] offset:25600
  ds_write_b128 v84, v[16:19] offset:24576
  ds_write_b128 v84, v[80:83] offset:25600
PG_kz_ker_96:
  ds_read_b32 v41, v37
  s_waitcnt lgkmcnt(0)
  v_cmp_le_u32 vcc, 0xb001, v41
  s_cmp_eq_u64 vcc, -1
  s_cbranch_scc1 PGD_kz_ker_97
  s_sleep 2
  s_sub_u32 s60, s60, 1
  s_cbranch_scc0 PG_kz_ker_96
  s_mov_b32 s60, 0
PGD_kz_ker_97:
  s_add_u32 m0, s46, 40960
  s_nop 0
  buffer_load_dwordx4 v32, s[24:27], s51 offen lds
  buffer_load_dwordx4 v33, s[24:27], s51 offen offset:1024 lds
  s_add_u32 m0, s46, 106496
  s_nop 0
  buffer_load_dwordx4 v34, s[28:31], s51 offen lds
  buffer_load_dwordx4 v35, s[28:31], s51 offen offset:1024 lds
  s_add_u32 s51, s51, 229376
  s_getpc_b64 s[38:39]
PC_kz_ker_98:
  s_sub_u32 s38, s38, PC_kz_ker_98-kz_kernel
  s_subb_u32 s39, s39, 0
  s_lshl_b32 s40, s5, 2
  s_add_u32 s40, s40, s3
  s_lshl_b32 s40, s40, 9
  s_waitcnt vmcnt(11)
  v_and_b32 v43, 7, v1
  v_lshlrev_b32 v43, 6, v43
  v_add_u32 v43, s40, v43
  v_min_u32 v43, kz_kernel_exit-kz_kernel, v43
  global_load_dword v43, v43, s[38:39]
  s_lshl_b32 s38, s4, 2
  s_add_u32 s38, s38, s7
  s_lshl_b32 s38, s38, 2
  s_add_u32 s38, s38, s3
  s_lshl_b32 s38, s38, 14
  s_lshl_b32 s39, s6, 7
  s_add_u32 s38, s38, s39
  s_waitcnt vmcnt(11)
  v_bfe_u32 v44, v1, 1, 4
  v_lshlrev_b32 v44, 10, v44
  s_waitcnt vmcnt(10)
  v_and_b32 v45, 1, v1
  v_lshl_or_b32 v44, v45, 6, v44
  buffer_load_dword v44, v44, s[20:23], s38 offen
  v_and_b32 v45, 15, v1
  v_lshlrev_b32 v45, 6, v45
  s_waitcnt vmcnt(10)
  v_lshrrev_b32 v46, 4, v1
  v_lshl_or_b32 v85, v46, 12, v45
  v_and_b32 v46, 1, v46
  v_lshl_or_b32 v45, v46, 15, v45
  s_lshl_b32 s38, s4, 2
  s_add_u32 s38, s38, s3
  s_lshl_b32 s38, s38, 6
  s_add_u32 s38, s38, s5
  s_lshl_b32 s38, s38, 10
  s_add_u32 s38, s38, 0xc00000
  s_and_b32 s39, s5, 1
  s_lshl_b32 s39, s39, 2
  s_add_u32 s39, s39, s3
  s_lshl_b32 s38, s4, 3
  s_add_u32 s39, s39, s38
  s_lshr_b32 s38, s5, 3
  s_mul_i32 s38, s38, 29
  s_bfe_u32 s40, s5, 0x20001
  s_add_u32 s38, s38, s40
  s_mul_i32 s40, s39, 116
  s_add_u32 s40, s40, s38
  s_lshl_b32 s40, s40, 10
  s_add_u32 s40, s40, 0x1200000
  buffer_load_dword v46, v85, s[8:11], s40 offen sc1
  s_xor_b32 s39, s39, 4
  s_mul_i32 s40, s39, 116
  s_add_u32 s40, s40, s38
  s_lshl_b32 s40, s40, 10
  s_add_u32 s40, s40, 0x1204000
  buffer_load_dword v85, v85, s[8:11], s40 offen sc1
  s_lshl_b32 s38, s4, 2
  s_add_u32 s38, s38, s7
  s_lshl_b32 s41, s38, 2
  s_add_u32 s41, s41, s3
  s_lshl_b32 s41, s41, 9
  s_add_u32 s41, s41, 0x202b400
  s_lshr_b32 s39, s3, 1
  s_lshl_b32 s38, s38, 1
  s_add_u32 s38, s38, s39
  s_lshl_b32 s39, s38, 12
  s_lshl_b32 s40, s6, 9
  s_add_u32 s39, s39, s40
  s_add_u32 s39, s39, 0xfff800
  s_lshl_b32 s40, s38, 7
  s_add_u32 s40, s40, 0x2027600
  s_mul_i32 s38, s38, 33792
  s_add_u32 s38, s38, 0x1a00000
  s_and_b32 s42, s3, 1
  s_lshl_b32 s43, s6, 1
  s_add_u32 s42, s42, s43
  s_lshl_b32 s42, s42, 11
  s_add_u32 s38, s38, s42
  v_mov_b32 v86, s38
  v_mov_b32 v87, s39
  v_cmp_le_u32 vcc, 32, v1
  s_nop 1
  v_cndmask_b32 v86, v86, v87, vcc
  v_mov_b32 v87, s40
  v_cmp_le_u32 vcc, 40, v1
  s_nop 1
  v_cndmask_b32 v86, v86, v87, vcc
  v_mov_b32 v87, s41
  v_cmp_le_u32 vcc, 48, v1
  s_nop 1
  v_cndmask_b32 v86, v86, v87, vcc
  v_lshl_add_u32 v86, v1, 6, v86
  buffer_load_dword v86, v86, s[8:11], 0 offen sc1
  s_waitcnt vmcnt(9)
  ds_read_b64_tr_b16 v[8:9], v31 offset:32768
  ds_read_b64_tr_b16 v[10:11], v31 offset:33280
  ds_read_b64_tr_b16 v[12:13], v38 offset:32768
  ds_read_b64_tr_b16 v[14:15], v38 offset:33280
  ds_read_b64_tr_b16 v[16:17], v39 offset:32768
  ds_read_b64_tr_b16 v[18:19], v39 offset:33280
  ds_read_b64_tr_b16 v[80:81], v40 offset:32768
  ds_read_b64_tr_b16 v[82:83], v40 offset:33280
  s_waitcnt lgkmcnt(6)
  v_mfma_f32_32x32x16_bf16 v[48:63], v[64:67], v[8:11], v[48:63]
  s_waitcnt lgkmcnt(4)
  v_mfma_f32_32x32x16_bf16 v[48:63], v[68:71], v[12:15], v[48:63]
  s_waitcnt lgkmcnt(2)
  v_mfma_f32_32x32x16_bf16 v[48:63], v[72:75], v[16:19], v[48:63]
  s_waitcnt lgkmcnt(0)
  v_mfma_f32_32x32x16_bf16 v[48:63], v[76:79], v[80:83], v[48:63]
  ds_write_b128 v47, v[8:11] offset:32768
  ds_write_b128 v47, v[12:15] offset:33792
  ds_write_b128 v84, v[16:19] offset:32768
  ds_write_b128 v84, v[80:83] offset:33792
PG_kz_ker_99:
  ds_read_b32 v41, v37
  s_waitcnt lgkmcnt(0)
  v_cmp_le_u32 vcc, 0xd001, v41
  s_cmp_eq_u64 vcc, -1
  s_cbranch_scc1 PGD_kz_ker_100
  s_sleep 2
  s_sub_u32 s60, s60, 1
  s_cbranch_scc0 PG_kz_ker_99
  s_mov_b32 s60, 0
PGD_kz_ker_100:
  s_add_u32 m0, s46, 49152
  s_nop 0
  buffer_load_dwordx4 v32, s[24:27], s51 offen lds
  buffer_load_dwordx4 v33, s[24:27], s51 offen offset:1024 lds
  s_add_u32 m0, s46, 114688
  s_nop 0
  buffer_load_dwordx4 v34, s[28:31], s51 offen lds
  buffer_load_dwordx4 v35, s[28:31], s51 offen offset:1024 lds
  s_add_u32 s51, s51, 229376
  s_waitcnt vmcnt(9)
  ds_read_b64_tr_b16 v[8:9], v31 offset:40960
  ds_read_b64_tr_b16 v[10:11], v31 offset:41472
  ds_read_b64_tr_b16 v[12:13], v38 offset:40960
  ds_read_b64_tr_b16 v[14:15], v38 offset:41472
  ds_read_b64_tr_b16 v[16:17], v39 offset:40960
  ds_read_b64_tr_b16 v[18:19], v39 offset:41472
  ds_read_b64_tr_b16 v[80:81], v40 offset:40960
  ds_read_b64_tr_b16 v[82:83], v40 offset:41472
  s_waitcnt lgkmcnt(6)
  v_mfma_f32_32x32x16_bf16 v[48:63], v[64:67], v[8:11], v[48:63]
  s_waitcnt lgkmcnt(4)
  v_mfma_f32_32x32x16_bf16 v[48:63], v[68:71], v[12:15], v[48:63]
  s_waitcnt lgkmcnt(2)
  v_mfma_f32_32x32x16_bf16 v[48:63], v[72:75], v[16:19], v[48:63]
  s_waitcnt lgkmcnt(0)
  v_mfma_f32_32x32x16_bf16 v[48:63], v[76:79], v[80:83], v[48:63]
  ds_write_b128 v47, v[8:11] offset:40960
  ds_write_b128 v47, v[12:15] offset:41984
  ds_write_b128 v84, v[16:19] offset:40960
  ds_write_b128 v84, v[80:83] offset:41984
PG_kz_ker_101:
  ds_read_b32 v41, v37
  s_waitcnt lgkmcnt(0)
  v_cmp_le_u32 vcc, 0xf001, v41
  s_cmp_eq_u64 vcc, -1
  s_cbranch_scc1 PGD_kz_ker_102
  s_sleep 2
  s_sub_u32 s60, s60, 1
  s_cbranch_scc0 PG_kz_ker_101
  s_mov_b32 s60, 0
PGD_kz_ker_102:
  s_add_u32 m0, s46, 57344
  s_nop 0
  buffer_load_dwordx4 v32, s[24:27], s51 offen lds
  buffer_load_dwordx4 v33, s[24:27], s51 offen offset:1024 lds
  s_add_u32 m0, s46, 122880
  s_nop 0
  buffer_load_dwordx4 v34, s[28:31], s51 offen lds
  buffer_load_dwordx4 v35, s[28:31], s51 offen offset:1024 lds
  s_add_u32 s51, s51, 229376
  s_waitcnt vmcnt(4)
  ds_read_b64_tr_b16 v[8:9], v31 offset:49152
  ds_read_b64_tr_b16 v[10:11], v31 offset:49664
  ds_read_b64_tr_b16 v[12:13], v38 offset:49152
  ds_read_b64_tr_b16 v[14:15], v38 offset:49664
  ds_read_b64_tr_b16 v[16:17], v39 offset:49152
  ds_read_b64_tr_b16 v[18:19], v39 offset:49664
  ds_read_b64_tr_b16 v[80:81], v40 offset:49152
  ds_read_b64_tr_b16 v[82:83], v40 offset:49664
  s_waitcnt lgkmcnt(6)
  v_mfma_f32_32x32x16_bf16 v[48:63], v[64:67], v[8:11], v[48:63]
  s_waitcnt lgkmcnt(4)
  v_mfma_f32_32x32x16_bf16 v[48:63], v[68:71], v[12:15], v[48:63]
  s_waitcnt lgkmcnt(2)
  v_mfma_f32_32x32x16_bf16 v[48:63], v[72:75], v[16:19], v[48:63]
  s_waitcnt lgkmcnt(0)
  v_mfma_f32_32x32x16_bf16 v[48:63], v[76:79], v[80:83], v[48:63]
  ds_write_b128 v47, v[8:11] offset:49152
  ds_write_b128 v47, v[12:15] offset:50176
  ds_write_b128 v84, v[16:19] offset:49152
  ds_write_b128 v84, v[80:83] offset:50176
  s_barrier
  s_waitcnt vmcnt(0)
  ds_read_b64_tr_b16 v[8:9], v31 offset:57344
  ds_read_b64_tr_b16 v[10:11], v31 offset:57856
  ds_read_b64_tr_b16 v[12:13], v38 offset:57344
  ds_read_b64_tr_b16 v[14:15], v38 offset:57856
  ds_read_b64_tr_b16 v[16:17], v39 offset:57344
  ds_read_b64_tr_b16 v[18:19], v39 offset:57856
  ds_read_b64_tr_b16 v[80:81], v40 offset:57344
  ds_read_b64_tr_b16 v[82:83], v40 offset:57856
  s_waitcnt lgkmcnt(6)
  v_mfma_f32_32x32x16_bf16 v[48:63], v[64:67], v[8:11], v[48:63]
  s_waitcnt lgkmcnt(4)
  v_mfma_f32_32x32x16_bf16 v[48:63], v[68:71], v[12:15], v[48:63]
  s_waitcnt lgkmcnt(2)
  v_mfma_f32_32x32x16_bf16 v[48:63], v[72:75], v[16:19], v[48:63]
  s_waitcnt lgkmcnt(0)
  v_mfma_f32_32x32x16_bf16 v[48:63], v[76:79], v[80:83], v[48:63]
  ds_write_b128 v47, v[8:11] offset:57344
  ds_write_b128 v47, v[12:15] offset:58368
  ds_write_b128 v84, v[16:19] offset:57344
  ds_write_b128 v84, v[80:83] offset:58368
  s_nop 7
  ds_write_b32 v42, v48 offset:0
  ds_write_b32 v42, v52 offset:512
  ds_write_b32 v42, v56 offset:1024
  ds_write_b32 v42, v60 offset:1536
  s_waitcnt lgkmcnt(0)
  v_lshrrev_b32 v86, 4, v1
  s_mov_b32 s38, 0x1c000
  v_mul_u32_u24 v86, s38, v86
  v_and_b32 v3, 15, v1
  v_lshl_add_u32 v86, v3, 10, v86
  v_mov_b32 v0, v20
  v_mov_b32 v1, v21
  v_lshrrev_b32 v3, 1, v2
  s_lshl_b32 s38, s46, 1
  s_add_u32 s38, s38, 98304
  v_add_u32 v4, s38, v27
  v_xor_b32 v5, 64, v4
  s_mul_i32 s43, s3, 6144
  s_lshl_b32 s38, s4, 2
  s_add_u32 s38, s38, s7
  s_lshl_b32 s42, s38, 2
  s_add_u32 s42, s42, s3
  s_lshl_b32 s42, s42, 9
  s_add_u32 s42, s42, 0x202c000
  s_lshr_b32 s39, s3, 1
  s_lshl_b32 s38, s38, 1
  s_add_u32 s38, s38, s39
  s_xor_b32 s39, s38, 1
  s_mul_i32 s47, s3, 29
  s_mul_i32 s40, s38, 116
  s_add_u32 s40, s40, s47
  s_lshl_b32 s40, s40, 10
  s_add_u32 s40, s40, 0x1200000
  s_mul_i32 s41, s39, 116
  s_add_u32 s41, s41, s47
  s_lshl_b32 s41, s41, 10
  s_add_u32 s41, s41, 0x1200000
  s_and_b32 s39, s3, 1
  s_lshl_b32 s47, s6, 1
  s_add_u32 s39, s39, s47
  s_mul_i32 s47, s38, 33792
  s_lshl_b32 s38, s38, 15
  s_lshl_b32 s50, s39, 11
  s_add_u32 s50, s50, s47
  s_add_u32 s50, s50, 0x1a00000
  s_lshl_b32 s51, s39, 6
  s_add_u32 s51, s51, s38
  s_barrier
  s_barrier
  s_mov_b32 s52, 0xf00000ff
  s_mov_b32 s53, 0xf
PL_kz_ker_103:
  buffer_load_dwordx2 v[6:7], v3, s[8:11], s42 offen sc1
  s_waitcnt vmcnt(0)
  v_cmp_eq_u64 s[44:45], s[56:57], v[6:7]
  s_andn2_b64 s[62:63], s[52:53], s[44:45]
  s_cmp_eq_u64 s[62:63], 0
  s_cbranch_scc1 PD_kz_ker_104
  s_sub_u32 s60, s60, 1
  s_cbranch_scc0 PL_kz_ker_103
  s_mov_b32 s60, 0
PD_kz_ker_104:
  buffer_load_dwordx4 v[24:27], v2, s[8:11], s50 offen offset:0 sc1
  buffer_load_dwordx4 v[28:31], v2, s[8:11], s50 offen offset:1024 sc1
  s_add_u32 s38, s49, 0x30000
  s_add_u32 m0, s43, 0x20000
  s_nop 0
  buffer_load_dwordx4 v0, s[16:19], s38 offen lds
  buffer_load_dwordx4 v1, s[16:19], s38 offen offset:1024 lds
  s_add_u32 s38, s49, 0x4c000
  s_add_u32 m0, s43, 0x20800
  s_nop 0
  buffer_load_dwordx4 v0, s[16:19], s38 offen lds
  buffer_load_dwordx4 v1, s[16:19], s38 offen offset:1024 lds
  s_add_u32 s38, s49, 0x68000
  s_add_u32 m0, s43, 0x21000
  s_nop 0
  buffer_load_dwordx4 v0, s[16:19], s38 offen lds
  buffer_load_dwordx4 v1, s[16:19], s38 offen offset:1024 lds
  s_add_u32 s38, s49, 98304
  buffer_load_dword v87, v86, s[16:19], s38 offen
  buffer_load_dword v86, v86, s[16:19], s38 offen offset:64
  buffer_load_dwordx4 v[72:75], v2, s[8:11], s40 offen offset:0 sc1
  buffer_load_dwordx4 v[76:79], v2, s[8:11], s41 offen offset:0 sc1
  buffer_load_dwordx4 v[80:83], v2, s[8:11], s40 offen offset:1024 sc1
  s_waitcnt vmcnt(3)
  buffer_load_dwordx4 v[84:87], v2, s[8:11], s41 offen offset:1024 sc1
  v_lshlrev_b32 v8, 16, v24
  v_and_b32 v9, 0xffff0000, v24
  v_lshlrev_b32 v10, 16, v25
  v_and_b32 v11, 0xffff0000, v25
  v_lshlrev_b32 v12, 16, v26
  v_and_b32 v13, 0xffff0000, v26
  v_lshlrev_b32 v14, 16, v27
  v_and_b32 v15, 0xffff0000, v27
  v_lshlrev_b32 v16, 16, v28
  v_and_b32 v17, 0xffff0000, v28
  v_lshlrev_b32 v18, 16, v29
  v_and_b32 v19, 0xffff0000, v29
  v_lshlrev_b32 v20, 16, v30
  v_and_b32 v21, 0xffff0000, v30
  v_lshlrev_b32 v22, 16, v31
  v_and_b32 v23, 0xffff0000, v31
  s_waitcnt vmcnt(3)
  s_nop 0
  v_mfma_f32_32x32x16_bf16 v[8:23], v[88:91], v[72:75], v[8:23]
  v_mfma_f32_32x32x16_bf16 v[24:39], v[92:95], v[72:75], 0
  buffer_load_dwordx4 v[72:75], v2, s[8:11], s40 offen offset:2048 sc1
  s_waitcnt vmcnt(3)
  v_mfma_f32_32x32x16_bf16 v[40:55], v[88:91], v[76:79], 0
  buffer_load_dwordx4 v[88:91], v2, s[8:11], s41 offen offset:2048 sc1
  v_mfma_f32_32x32x16_bf16 v[56:71], v[92:95], v[76:79], 0
  buffer_load_dwordx4 v[76:79], v2, s[8:11], s40 offen offset:3072 sc1
  buffer_load_dwordx4 v[92:95], v2, s[8:11], s41 offen offset:3072 sc1
  s_waitcnt vmcnt(5)
  v_mfma_f32_32x32x16_bf16 v[8:23], v[96:99], v[80:83], v[8:23]
  v_mfma_f32_32x32x16_bf16 v[24:39], v[100:103], v[80:83], v[24:39]
  s_add_u32 s40, s40, 0x1000
  buffer_load_dwordx4 v[80:83], v2, s[8:11], s40 offen offset:0 sc1
  s_waitcnt vmcnt(5)
  v_mfma_f32_32x32x16_bf16 v[40:55], v[96:99], v[84:87], v[40:55]
  s_add_u32 s41, s41, 0x1000
  buffer_load_dwordx4 v[96:99], v2, s[8:11], s41 offen offset:0 sc1
  v_mfma_f32_32x32x16_bf16 v[56:71], v[100:103], v[84:87], v[56:71]
  buffer_load_dwordx4 v[84:87], v2, s[8:11], s40 offen offset:1024 sc1
  buffer_load_dwordx4 v[100:103], v2, s[8:11], s41 offen offset:1024 sc1
  s_waitcnt vmcnt(7)
  v_mfma_f32_32x32x16_bf16 v[8:23], v[104:107], v[72:75], v[8:23]
  v_mfma_f32_32x32x16_bf16 v[24:39], v[108:111], v[72:75], v[24:39]
  buffer_load_dwordx4 v[72:75], v2, s[8:11], s40 offen offset:2048 sc1
  s_waitcnt vmcnt(7)
  v_mfma_f32_32x32x16_bf16 v[40:55], v[104:107], v[88:91], v[40:55]
  buffer_load_dwordx4 v[104:107], v2, s[8:11], s41 offen offset:2048 sc1
  v_mfma_f32_32x32x16_bf16 v[56:71], v[108:111], v[88:91], v[56:71]
  buffer_load_dwordx4 v[88:91], v2, s[8:11], s40 offen offset:3072 sc1
  buffer_load_dwordx4 v[108:111], v2, s[8:11], s41 offen offset:3072 sc1
  s_waitcnt vmcnt(9)
  v_mfma_f32_32x32x16_bf16 v[8:23], v[112:115], v[76:79], v[8:23]
  v_mfma_f32_32x32x16_bf16 v[24:39], v[116:119], v[76:79], v[24:39]
  s_waitcnt vmcnt(8)
  v_mfma_f32_32x32x16_bf16 v[40:55], v[112:115], v[92:95], v[40:55]
  v_mfma_f32_32x32x16_bf16 v[56:71], v[116:119], v[92:95], v[56:71]
  s_waitcnt vmcnt(7)
  v_mfma_f32_32x32x16_bf16 v[8:23], v[120:123], v[80:83], v[8:23]
  v_mfma_f32_32x32x16_bf16 v[24:39], v[124:127], v[80:83], v[24:39]
  s_waitcnt vmcnt(6)
  v_mfma_f32_32x32x16_bf16 v[40:55], v[120:123], v[96:99], v[40:55]
  v_mfma_f32_32x32x16_bf16 v[56:71], v[124:127], v[96:99], v[56:71]
  s_waitcnt vmcnt(5)
  v_mfma_f32_32x32x16_bf16 v[8:23], v[128:131], v[84:87], v[8:23]
  v_mfma_f32_32x32x16_bf16 v[24:39], v[132:135], v[84:87], v[24:39]
  buffer_load_dwordx2 v[6:7], v3, s[8:11], s42 offen sc1
  s_waitcnt vmcnt(5)
  v_mfma_f32_32x32x16_bf16 v[40:55], v[128:131], v[100:103], v[40:55]
  v_mfma_f32_32x32x16_bf16 v[56:71], v[132:135], v[100:103], v[56:71]
  s_waitcnt vmcnt(4)
  v_mfma_f32_32x32x16_bf16 v[8:23], v[136:139], v[72:75], v[8:23]
  v_mfma_f32_32x32x16_bf16 v[24:39], v[140:143], v[72:75], v[24:39]
  s_waitcnt vmcnt(3)
  v_mfma_f32_32x32x16_bf16 v[40:55], v[136:139], v[104:107], v[40:55]
  v_mfma_f32_32x32x16_bf16 v[56:71], v[140:143], v[104:107], v[56:71]
  s_mov_b32 s52, 0xff00
  s_mov_b32 s53, 0xff0
  s_waitcnt vmcnt(0)
  v_cmp_eq_u64 s[44:45], s[56:57], v[6:7]
  s_andn2_b64 s[62:63], s[52:53], s[44:45]
  s_cmp_eq_u64 s[62:63], 0
  s_cbranch_scc0 RP_kz_ker_105
RB_kz_ker_106:
  s_add_u32 s40, s40, 0x1000
  buffer_load_dwordx4 v[76:79], v2, s[8:11], s40 offen offset:0 sc1
  s_add_u32 s41, s41, 0x1000
  buffer_load_dwordx4 v[112:115], v2, s[8:11], s41 offen offset:0 sc1
  buffer_load_dwordx4 v[92:95], v2, s[8:11], s40 offen offset:1024 sc1
  buffer_load_dwordx4 v[116:119], v2, s[8:11], s41 offen offset:1024 sc1
  buffer_load_dwordx4 v[80:83], v2, s[8:11], s40 offen offset:2048 sc1
  buffer_load_dwordx4 v[96:99], v2, s[8:11], s41 offen offset:2048 sc1
  buffer_load_dwordx4 v[84:87], v2, s[8:11], s40 offen offset:3072 sc1
  buffer_load_dwordx4 v[100:103], v2, s[8:11], s41 offen offset:3072 sc1
  s_add_u32 s40, s40, 0x1000
  buffer_load_dwordx4 v[72:75], v2, s[8:11], s40 offen offset:0 sc1
  s_add_u32 s41, s41, 0x1000
  buffer_load_dwordx4 v[104:107], v2, s[8:11], s41 offen offset:0 sc1
  v_mfma_f32_32x32x16_bf16 v[8:23], v[144:147], v[88:91], v[8:23]
  s_waitcnt vmcnt(29)
  ds_read_b64_tr_b16 v[120:121], v4 offset:0
  ds_read_b64_tr_b16 v[122:123], v4 offset:512
  ds_read_b64_tr_b16 v[124:125], v5 offset:0
  ds_read_b64_tr_b16 v[126:127], v5 offset:512
  ds_read_b64_tr_b16 v[128:129], v4 offset:2048
  ds_read_b64_tr_b16 v[130:131], v4 offset:2560
  ds_read_b64_tr_b16 v[132:133], v5 offset:2048
  ds_read_b64_tr_b16 v[134:135], v5 offset:2560
  ds_read_b64_tr_b16 v[136:137], v4 offset:4096
  ds_read_b64_tr_b16 v[138:139], v4 offset:4608
  ds_read_b64_tr_b16 v[140:141], v5 offset:4096
  ds_read_b64_tr_b16 v[142:143], v5 offset:4608
  v_mfma_f32_32x32x16_bf16 v[24:39], v[148:151], v[88:91], v[24:39]
  buffer_load_dwordx4 v[88:91], v2, s[8:11], s40 offen offset:1024 sc1
  v_mfma_f32_32x32x16_bf16 v[40:55], v[144:147], v[108:111], v[40:55]
  v_mfma_f32_32x32x16_bf16 v[56:71], v[148:151], v[108:111], v[56:71]
  buffer_load_dwordx4 v[108:111], v2, s[8:11], s41 offen offset:1024 sc1
  s_waitcnt lgkmcnt(0)
  s_add_u32 s38, s49, 0x18000
  s_add_u32 m0, s43, 0x20000
  s_nop 0
  buffer_load_dwordx4 v0, s[16:19], s38 offen lds
  buffer_load_dwordx4 v1, s[16:19], s38 offen offset:1024 lds
  s_add_u32 s38, s49, 0x34000
  s_add_u32 m0, s43, 0x20800
  s_nop 0
  buffer_load_dwordx4 v0, s[16:19], s38 offen lds
  buffer_load_dwordx4 v1, s[16:19], s38 offen offset:1024 lds
  s_add_u32 s38, s49, 0x50000
  s_add_u32 m0, s43, 0x21000
  s_nop 0
  buffer_load_dwordx4 v0, s[16:19], s38 offen lds
  buffer_load_dwordx4 v1, s[16:19], s38 offen offset:1024 lds
  s_waitcnt vmcnt(17)
  v_mfma_f32_32x32x16_bf16 v[8:23], v[152:155], v[76:79], v[8:23]
  v_mfma_f32_32x32x16_bf16 v[24:39], v[156:159], v[76:79], v[24:39]
  buffer_load_dwordx4 v[76:79], v2, s[8:11], s40 offen offset:2048 sc1
  s_waitcnt vmcnt(17)
  v_mfma_f32_32x32x16_bf16 v[40:55], v[152:155], v[112:115], v[40:55]
  v_mfma_f32_32x32x16_bf16 v[56:71], v[156:159], v[112:115], v[56:71]
  buffer_load_dwordx4 v[112:115], v2, s[8:11], s41 offen offset:2048 sc1
  s_waitcnt vmcnt(17)
  v_mfma_f32_32x32x16_bf16 v[8:23], v[160:163], v[92:95], v[8:23]
  v_mfma_f32_32x32x16_bf16 v[24:39], v[164:167], v[92:95], v[24:39]
  buffer_load_dwordx4 v[92:95], v2, s[8:11], s40 offen offset:3072 sc1
  s_waitcnt vmcnt(17)
  v_mfma_f32_32x32x16_bf16 v[40:55], v[160:163], v[116:119], v[40:55]
  v_mfma_f32_32x32x16_bf16 v[56:71], v[164:167], v[116:119], v[56:71]
  buffer_load_dwordx4 v[116:119], v2, s[8:11], s41 offen offset:3072 sc1
  s_waitcnt vmcnt(17)
  v_mfma_f32_32x32x16_bf16 v[8:23], v[168:171], v[80:83], v[8:23]
  v_mfma_f32_32x32x16_bf16 v[24:39], v[172:175], v[80:83], v[24:39]
  buffer_load_dwordx2 v[6:7], v3, s[8:11], s42 offen sc1
  s_waitcnt vmcnt(17)
  v_mfma_f32_32x32x16_bf16 v[40:55], v[168:171], v[96:99], v[40:55]
  v_mfma_f32_32x32x16_bf16 v[56:71], v[172:175], v[96:99], v[56:71]
  s_waitcnt vmcnt(16)
  v_mfma_f32_32x32x16_bf16 v[8:23], v[176:179], v[84:87], v[8:23]
  v_mfma_f32_32x32x16_bf16 v[24:39], v[180:183], v[84:87], v[24:39]
  s_waitcnt vmcnt(15)
  v_mfma_f32_32x32x16_bf16 v[40:55], v[176:179], v[100:103], v[40:55]
  v_mfma_f32_32x32x16_bf16 v[56:71], v[180:183], v[100:103], v[56:71]
  s_mov_b32 s52, 0xf0000
  s_mov_b32 s53, 0xf000
  s_waitcnt vmcnt(0)
  v_cmp_eq_u64 s[44:45], s[56:57], v[6:7]
  s_andn2_b64 s[62:63], s[52:53], s[44:45]
  s_cmp_eq_u64 s[62:63], 0
  s_cbranch_scc0 RP_kz_ker_107
RB_kz_ker_108:
  s_add_u32 s40, s40, 0x1000
  buffer_load_dwordx4 v[80:83], v2, s[8:11], s40 offen offset:0 sc1
  s_add_u32 s41, s41, 0x1000
  buffer_load_dwordx4 v[96:99], v2, s[8:11], s41 offen offset:0 sc1
  buffer_load_dwordx4 v[84:87], v2, s[8:11], s40 offen offset:1024 sc1
  buffer_load_dwordx4 v[100:103], v2, s[8:11], s41 offen offset:1024 sc1
  v_mfma_f32_32x32x16_bf16 v[8:23], v[184:187], v[72:75], v[8:23]
  v_mfma_f32_32x32x16_bf16 v[24:39], v[188:191], v[72:75], v[24:39]
  buffer_load_dwordx4 v[72:75], v2, s[8:11], s40 offen offset:2048 sc1
  v_mfma_f32_32x32x16_bf16 v[40:55], v[184:187], v[104:107], v[40:55]
  v_mfma_f32_32x32x16_bf16 v[56:71], v[188:191], v[104:107], v[56:71]
  buffer_load_dwordx4 v[104:107], v2, s[8:11], s41 offen offset:2048 sc1
  v_mfma_f32_32x32x16_bf16 v[8:23], v[192:195], v[88:91], v[8:23]
  v_mfma_f32_32x32x16_bf16 v[24:39], v[196:199], v[88:91], v[24:39]
  buffer_load_dwordx4 v[88:91], v2, s[8:11], s40 offen offset:3072 sc1
  v_mfma_f32_32x32x16_bf16 v[40:55], v[192:195], v[108:111], v[40:55]
  v_mfma_f32_32x32x16_bf16 v[56:71], v[196:199], v[108:111], v[56:71]
  buffer_load_dwordx4 v[108:111], v2, s[8:11], s41 offen offset:3072 sc1
  s_waitcnt vmcnt(13)
  ds_read_b64_tr_b16 v[144:145], v4 offset:0
  ds_read_b64_tr_b16 v[146:147], v4 offset:512
  ds_read_b64_tr_b16 v[148:149], v5 offset:0
  ds_read_b64_tr_b16 v[150:151], v5 offset:512
  ds_read_b64_tr_b16 v[152:153], v4 offset:2048
  ds_read_b64_tr_b16 v[154:155], v4 offset:2560
  ds_read_b64_tr_b16 v[156:157], v5 offset:2048
  ds_read_b64_tr_b16 v[158:159], v5 offset:2560
  ds_read_b64_tr_b16 v[160:161], v4 offset:4096
  ds_read_b64_tr_b16 v[162:163], v4 offset:4608
  ds_read_b64_tr_b16 v[164:165], v5 offset:4096
  ds_read_b64_tr_b16 v[166:167], v5 offset:4608
  v_mfma_f32_32x32x16_bf16 v[8:23], v[200:203], v[76:79], v[8:23]
  v_mfma_f32_32x32x16_bf16 v[24:39], v[204:207], v[76:79], v[24:39]
  buffer_load_dwordx2 v[6:7], v3, s[8:11], s42 offen sc1
  v_mfma_f32_32x32x16_bf16 v[40:55], v[200:203], v[112:115], v[40:55]
  s_waitcnt lgkmcnt(0)
  s_add_u32 s38, s49, 0x6c000
  s_add_u32 m0, s43, 0x20000
  s_nop 0
  buffer_load_dwordx4 v0, s[16:19], s38 offen lds
  buffer_load_dwordx4 v1, s[16:19], s38 offen offset:1024 lds
  v_mfma_f32_32x32x16_bf16 v[56:71], v[204:207], v[112:115], v[56:71]
  v_mfma_f32_32x32x16_bf16 v[8:23], v[208:211], v[92:95], v[8:23]
  v_mfma_f32_32x32x16_bf16 v[24:39], v[212:215], v[92:95], v[24:39]
  v_mfma_f32_32x32x16_bf16 v[40:55], v[208:211], v[116:119], v[40:55]
  v_mfma_f32_32x32x16_bf16 v[56:71], v[212:215], v[116:119], v[56:71]
  s_mov_b32 s52, 0xf00000
  s_mov_b32 s53, 0xf0000
  s_waitcnt vmcnt(2)
  v_cmp_eq_u64 s[44:45], s[56:57], v[6:7]
  s_andn2_b64 s[62:63], s[52:53], s[44:45]
  s_cmp_eq_u64 s[62:63], 0
  s_cbranch_scc0 RP_kz_ker_109
RB_kz_ker_110:
  s_add_u32 s40, s40, 0x1000
  buffer_load_dwordx4 v[76:79], v2, s[8:11], s40 offen offset:0 sc1
  s_add_u32 s41, s41, 0x1000
  buffer_load_dwordx4 v[200:203], v2, s[8:11], s41 offen offset:0 sc1
  buffer_load_dwordx4 v[112:115], v2, s[8:11], s40 offen offset:1024 sc1
  buffer_load_dwordx4 v[204:207], v2, s[8:11], s41 offen offset:1024 sc1
  buffer_load_dwordx4 v[92:95], v2, s[8:11], s40 offen offset:2048 sc1
  buffer_load_dwordx4 v[208:211], v2, s[8:11], s41 offen offset:2048 sc1
  buffer_load_dwordx4 v[116:119], v2, s[8:11], s40 offen offset:3072 sc1
  buffer_load_dwordx4 v[212:215], v2, s[8:11], s41 offen offset:3072 sc1
  v_mfma_f32_32x32x16_bf16 v[8:23], v[216:219], v[80:83], v[8:23]
  v_mfma_f32_32x32x16_bf16 v[24:39], v[220:223], v[80:83], v[24:39]
  v_mfma_f32_32x32x16_bf16 v[40:55], v[216:219], v[96:99], v[40:55]
  v_mfma_f32_32x32x16_bf16 v[56:71], v[220:223], v[96:99], v[56:71]
  v_mfma_f32_32x32x16_bf16 v[8:23], v[224:227], v[84:87], v[8:23]
  v_mfma_f32_32x32x16_bf16 v[24:39], v[228:231], v[84:87], v[24:39]
  v_mfma_f32_32x32x16_bf16 v[40:55], v[224:227], v[100:103], v[40:55]
  v_mfma_f32_32x32x16_bf16 v[56:71], v[228:231], v[100:103], v[56:71]
  v_mfma_f32_32x32x16_bf16 v[8:23], v[232:235], v[72:75], v[8:23]
  v_mfma_f32_32x32x16_bf16 v[24:39], v[236:239], v[72:75], v[24:39]
  buffer_load_dwordx2 v[6:7], v3, s[8:11], s42 offen sc1
  v_mfma_f32_32x32x16_bf16 v[40:55], v[232:235], v[104:107], v[40:55]
  v_mfma_f32_32x32x16_bf16 v[56:71], v[236:239], v[104:107], v[56:71]
  v_mfma_f32_32x32x16_bf16 v[8:23], v[240:243], v[88:91], v[8:23]
  v_mfma_f32_32x32x16_bf16 v[24:39], v[244:247], v[88:91], v[24:39]
  v_mfma_f32_32x32x16_bf16 v[40:55], v[240:243], v[108:111], v[40:55]
  v_mfma_f32_32x32x16_bf16 v[56:71], v[244:247], v[108:111], v[56:71]
  s_mov_b32 s52, 0xf000000
  s_mov_b32 s53, 0xf00000
  s_barrier
  s_waitcnt vmcnt(0)
  v_cmp_eq_u64 s[44:45], s[56:57], v[6:7]
  s_andn2_b64 s[62:63], s[52:53], s[44:45]
  s_cmp_eq_u64 s[62:63], 0
  s_cbranch_scc0 RP_kz_ker_111
RB_kz_ker_112:
  s_add_u32 s41, s41, 0x1000
  buffer_load_dwordx4 v[80:83], v2, s[8:11], s41 offen offset:0 sc1
  buffer_load_dwordx4 v[216:219], v2, s[8:11], s41 offen offset:1024 sc1
  buffer_load_dwordx4 v[96:99], v2, s[8:11], s41 offen offset:2048 sc1
  buffer_load_dwordx4 v[220:223], v2, s[8:11], s41 offen offset:3072 sc1
  s_add_u32 s40, s40, 0x1000
  buffer_load_dwordx4 v[84:87], v2, s[8:11], s40 offen offset:0 sc1
  buffer_load_dwordx4 v[224:227], v2, s[8:11], s40 offen offset:1024 sc1
  buffer_load_dwordx4 v[100:103], v2, s[8:11], s40 offen offset:2048 sc1
  buffer_load_dwordx4 v[228:231], v2, s[8:11], s40 offen offset:3072 sc1
  v_mfma_f32_32x32x16_bf16 v[8:23], v[248:251], v[76:79], v[8:23]
  v_mfma_f32_32x32x16_bf16 v[24:39], v[252:255], v[76:79], v[24:39]
  v_mfma_f32_32x32x16_bf16 v[40:55], v[248:251], v[200:203], v[40:55]
  v_mfma_f32_32x32x16_bf16 v[56:71], v[252:255], v[200:203], v[56:71]
  s_waitcnt vmcnt(17)
  ds_read_b64_tr_b16 v[168:169], v4 offset:0
  ds_read_b64_tr_b16 v[170:171], v4 offset:512
  ds_read_b64_tr_b16 v[172:173], v5 offset:0
  ds_read_b64_tr_b16 v[174:175], v5 offset:512
  v_mfma_f32_32x32x16_bf16 v[8:23], v[120:123], v[112:115], v[8:23]
  v_mfma_f32_32x32x16_bf16 v[24:39], v[124:127], v[112:115], v[24:39]
  v_mfma_f32_32x32x16_bf16 v[40:55], v[120:123], v[204:207], v[40:55]
  v_mfma_f32_32x32x16_bf16 v[56:71], v[124:127], v[204:207], v[56:71]
  v_mfma_f32_32x32x16_bf16 v[8:23], v[128:131], v[92:95], v[8:23]
  v_mfma_f32_32x32x16_bf16 v[24:39], v[132:135], v[92:95], v[24:39]
  v_mfma_f32_32x32x16_bf16 v[40:55], v[128:131], v[208:211], v[40:55]
  v_mfma_f32_32x32x16_bf16 v[56:71], v[132:135], v[208:211], v[56:71]
  v_mfma_f32_32x32x16_bf16 v[8:23], v[136:139], v[116:119], v[8:23]
  v_mfma_f32_32x32x16_bf16 v[24:39], v[140:143], v[116:119], v[24:39]
  v_mfma_f32_32x32x16_bf16 v[40:55], v[136:139], v[212:215], v[40:55]
  v_mfma_f32_32x32x16_bf16 v[56:71], v[140:143], v[212:215], v[56:71]
  s_waitcnt vmcnt(7)
  v_mfma_f32_32x32x16_bf16 v[40:55], v[144:147], v[80:83], v[40:55]
  s_waitcnt vmcnt(6)
  v_mfma_f32_32x32x16_bf16 v[40:55], v[152:155], v[216:219], v[40:55]
  s_xor_b32 s38, s3, 1
  s_mul_i32 s38, s38, 12288
  s_add_u32 s38, s38, 0
  v_add_u32 v3, s38, v2
  s_xor_b32 s38, s3, 2
  s_mul_i32 s38, s38, 12288
  s_add_u32 s38, s38, 4096
  v_add_u32 v4, s38, v2
  s_xor_b32 s38, s3, 3
  s_mul_i32 s38, s38, 12288
  s_add_u32 s38, s38, 8192
  v_add_u32 v5, s38, v2
  s_mul_i32 s38, s3, 12288
  v_add_u32 v6, s38, v2
  s_waitcnt vmcnt(5)
  v_mfma_f32_32x32x16_bf16 v[40:55], v[160:163], v[96:99], v[40:55]
  s_waitcnt vmcnt(4) lgkmcnt(2)
  v_mfma_f32_32x32x16_bf16 v[40:55], v[168:171], v[220:223], v[40:55]
  v_mfma_f32_32x32x16_bf16 v[56:71], v[148:151], v[80:83], v[56:71]
  v_mfma_f32_32x32x16_bf16 v[56:71], v[156:159], v[216:219], v[56:71]
  s_nop 9
  ds_write_b128 v4, v[40:43] offset:0
  ds_write_b128 v4, v[44:47] offset:1024
  ds_write_b128 v4, v[48:51] offset:2048
  ds_write_b128 v4, v[52:55] offset:3072
  v_mfma_f32_32x32x16_bf16 v[56:71], v[164:167], v[96:99], v[56:71]
  s_waitcnt lgkmcnt(4)
  v_mfma_f32_32x32x16_bf16 v[56:71], v[172:175], v[220:223], v[56:71]
  s_waitcnt vmcnt(3)
  v_mfma_f32_32x32x16_bf16 v[24:39], v[148:151], v[84:87], v[24:39]
  s_waitcnt vmcnt(2)
  v_mfma_f32_32x32x16_bf16 v[24:39], v[156:159], v[224:227], v[24:39]
  s_nop 7
  ds_write_b128 v5, v[56:59] offset:0
  ds_write_b128 v5, v[60:63] offset:1024
  ds_write_b128 v5, v[64:67] offset:2048
  ds_write_b128 v5, v[68:71] offset:3072
  s_waitcnt vmcnt(1)
  v_mfma_f32_32x32x16_bf16 v[24:39], v[164:167], v[100:103], v[24:39]
  s_waitcnt vmcnt(0)
  v_mfma_f32_32x32x16_bf16 v[24:39], v[172:175], v[228:231], v[24:39]
  v_mfma_f32_32x32x16_bf16 v[8:23], v[144:147], v[84:87], v[8:23]
  v_mfma_f32_32x32x16_bf16 v[8:23], v[152:155], v[224:227], v[8:23]
  s_nop 9
  ds_write_b128 v3, v[24:27] offset:0
  ds_write_b128 v3, v[28:31] offset:1024
  ds_write_b128 v3, v[32:35] offset:2048
  ds_write_b128 v3, v[36:39] offset:3072
  v_mfma_f32_32x32x16_bf16 v[8:23], v[160:163], v[100:103], v[8:23]
  v_mfma_f32_32x32x16_bf16 v[8:23], v[168:171], v[228:231], v[8:23]
  v_and_b32 v5, 0x1f0, v2
  v_lshrrev_b32 v4, 5, v2
  v_and_b32 v4, 16, v4
  v_lshl_or_b32 v5, v5, 6, v4
  s_waitcnt lgkmcnt(0)
  s_barrier
  ds_read_b128 v[88:91], v6 offset:0
  ds_read_b128 v[104:107], v6 offset:4096
  ds_read_b128 v[120:123], v6 offset:8192
  ds_read_b128 v[92:95], v6 offset:1024
  ds_read_b128 v[108:111], v6 offset:5120
  ds_read_b128 v[124:127], v6 offset:9216
  ds_read_b128 v[96:99], v6 offset:2048
  ds_read_b128 v[112:115], v6 offset:6144
  ds_read_b128 v[128:131], v6 offset:10240
  ds_read_b128 v[100:103], v6 offset:3072
  ds_read_b128 v[116:119], v6 offset:7168
  ds_read_b128 v[132:135], v6 offset:11264
  s_waitcnt lgkmcnt(10)
  v_pk_add_f32 v[88:89], v[88:89], v[104:105]
  s_waitcnt lgkmcnt(9)
  v_pk_add_f32 v[8:9], v[8:9], v[120:121]
  v_pk_add_f32 v[90:91], v[90:91], v[106:107]
  v_pk_add_f32 v[10:11], v[10:11], v[122:123]
  s_waitcnt lgkmcnt(7)
  v_pk_add_f32 v[92:93], v[92:93], v[108:109]
  s_waitcnt lgkmcnt(6)
  v_pk_add_f32 v[12:13], v[12:13], v[124:125]
  v_pk_add_f32 v[94:95], v[94:95], v[110:111]
  v_pk_add_f32 v[14:15], v[14:15], v[126:127]
  v_pk_add_f32 v[8:9], v[8:9], v[88:89]
  v_pk_add_f32 v[10:11], v[10:11], v[90:91]
  v_pk_add_f32 v[12:13], v[12:13], v[92:93]
  v_pk_add_f32 v[14:15], v[14:15], v[94:95]
  v_cvt_pk_bf16_f32 v72, v8, v9
  v_cvt_pk_bf16_f32 v73, v10, v11
  v_cvt_pk_bf16_f32 v74, v12, v13
  v_cvt_pk_bf16_f32 v75, v14, v15
  buffer_store_dwordx4 v[72:75], v5, s[12:15], s51 offen offset:0
  s_waitcnt lgkmcnt(4)
  v_pk_add_f32 v[96:97], v[96:97], v[112:113]
  s_waitcnt lgkmcnt(3)
  v_pk_add_f32 v[16:17], v[16:17], v[128:129]
  v_pk_add_f32 v[98:99], v[98:99], v[114:115]
  v_pk_add_f32 v[18:19], v[18:19], v[130:131]
  s_waitcnt lgkmcnt(1)
  v_pk_add_f32 v[100:101], v[100:101], v[116:117]
  s_waitcnt lgkmcnt(0)
  v_pk_add_f32 v[20:21], v[20:21], v[132:133]
  v_pk_add_f32 v[102:103], v[102:103], v[118:119]
  v_pk_add_f32 v[22:23], v[22:23], v[134:135]
  v_pk_add_f32 v[16:17], v[16:17], v[96:97]
  v_pk_add_f32 v[18:19], v[18:19], v[98:99]
  v_pk_add_f32 v[20:21], v[20:21], v[100:101]
  v_pk_add_f32 v[22:23], v[22:23], v[102:103]
  v_cvt_pk_bf16_f32 v76, v16, v17
  v_cvt_pk_bf16_f32 v77, v18, v19
  v_cvt_pk_bf16_f32 v78, v20, v21
  v_cvt_pk_bf16_f32 v79, v22, v23
  buffer_store_dwordx4 v[76:79], v5, s[12:15], s51 offen offset:32
  s_add_u32 s3, s3, 4
  s_branch END_kz_ker_2
RP_kz_ker_68:
  s_mov_b64 s[38:39], 12
PL_kz_ker_113:
  buffer_load_dwordx2 v[24:25], v3, s[8:11], s42 offen sc1
  s_waitcnt vmcnt(0)
  v_cmp_eq_u64 s[44:45], s[56:57], v[24:25]
  s_andn2_b64 s[62:63], s[38:39], s[44:45]
  s_cmp_eq_u64 s[62:63], 0
  s_cbranch_scc1 PD_kz_ker_114
  s_sub_u32 s60, s60, 1
  s_cbranch_scc0 PL_kz_ker_113
  s_mov_b32 s60, 0
PD_kz_ker_114:
  s_branch RB_kz_ker_69
RP_kz_ker_72:
  s_mov_b64 s[38:39], 48
PL_kz_ker_115:
  buffer_load_dwordx2 v[24:25], v3, s[8:11], s42 offen sc1
  s_waitcnt vmcnt(0)
  v_cmp_eq_u64 s[44:45], s[56:57], v[24:25]
  s_andn2_b64 s[62:63], s[38:39], s[44:45]
  s_cmp_eq_u64 s[62:63], 0
  s_cbranch_scc1 PD_kz_ker_116
  s_sub_u32 s60, s60, 1
  s_cbranch_scc0 PL_kz_ker_115
  s_mov_b32 s60, 0
PD_kz_ker_116:
  s_branch RB_kz_ker_73
RP_kz_ker_74:
  s_mov_b64 s[38:39], 192
PL_kz_ker_117:
  buffer_load_dwordx2 v[24:25], v3, s[8:11], s42 offen sc1
  s_waitcnt vmcnt(0)
  v_cmp_eq_u64 s[44:45], s[56:57], v[24:25]
  s_andn2_b64 s[62:63], s[38:39], s[44:45]
  s_cmp_eq_u64 s[62:63], 0
  s_cbranch_scc1 PD_kz_ker_118
  s_sub_u32 s60, s60, 1
  s_cbranch_scc0 PL_kz_ker_117
  s_mov_b32 s60, 0
PD_kz_ker_118:
  s_branch RB_kz_ker_75
RP_kz_ker_78:
  s_mov_b64 s[38:39], 768
PL_kz_ker_119:
  buffer_load_dwordx2 v[24:25], v3, s[8:11], s42 offen sc1
  s_waitcnt vmcnt(0)
  v_cmp_eq_u64 s[44:45], s[56:57], v[24:25]
  s_andn2_b64 s[62:63], s[38:39], s[44:45]
  s_cmp_eq_u64 s[62:63], 0
  s_cbranch_scc1 PD_kz_ker_120
  s_sub_u32 s60, s60, 1
  s_cbranch_scc0 PL_kz_ker_119
  s_mov_b32 s60, 0
PD_kz_ker_120:
  s_branch RB_kz_ker_79
RP_kz_ker_80:
  s_mov_b64 s[38:39], 3072
PL_kz_ker_121:
  buffer_load_dwordx2 v[24:25], v3, s[8:11], s42 offen sc1
  s_waitcnt vmcnt(0)
  v_cmp_eq_u64 s[44:45], s[56:57], v[24:25]
  s_andn2_b64 s[62:63], s[38:39], s[44:45]
  s_cmp_eq_u64 s[62:63], 0
  s_cbranch_scc1 PD_kz_ker_122
  s_sub_u32 s60, s60, 1
  s_cbranch_scc0 PL_kz_ker_121
  s_mov_b32 s60, 0
PD_kz_ker_122:
  s_branch RB_kz_ker_81
RP_kz_ker_82:
  s_mov_b64 s[38:39], 12288
PL_kz_ker_123:
  buffer_load_dwordx2 v[24:25], v3, s[8:11], s42 offen sc1
  s_waitcnt vmcnt(0)
  v_cmp_eq_u64 s[44:45], s[56:57], v[24:25]
  s_andn2_b64 s[62:63], s[38:39], s[44:45]
  s_cmp_eq_u64 s[62:63], 0
  s_cbranch_scc1 PD_kz_ker_124
  s_sub_u32 s60, s60, 1
  s_cbranch_scc0 PL_kz_ker_123
  s_mov_b32 s60, 0
PD_kz_ker_124:
  s_branch RB_kz_ker_83
RP_kz_ker_84:
  s_mov_b64 s[38:39], 49152
PL_kz_ker_125:
  buffer_load_dwordx2 v[24:25], v3, s[8:11], s42 offen sc1
  s_waitcnt vmcnt(0)
  v_cmp_eq_u64 s[44:45], s[56:57], v[24:25]
  s_andn2_b64 s[62:63], s[38:39], s[44:45]
  s_cmp_eq_u64 s[62:63], 0
  s_cbranch_scc1 PD_kz_ker_126
  s_sub_u32 s60, s60, 1
  s_cbranch_scc0 PL_kz_ker_125
  s_mov_b32 s60, 0
PD_kz_ker_126:
  s_branch RB_kz_ker_85
RP_kz_ker_105:
PL_kz_ker_127:
  buffer_load_dwordx2 v[6:7], v3, s[8:11], s42 offen sc1
  s_waitcnt vmcnt(0)
  v_cmp_eq_u64 s[44:45], s[56:57], v[6:7]
  s_andn2_b64 s[62:63], s[52:53], s[44:45]
  s_cmp_eq_u64 s[62:63], 0
  s_cbranch_scc1 PD_kz_ker_128
  s_sub_u32 s60, s60, 1
  s_cbranch_scc0 PL_kz_ker_127
  s_mov_b32 s60, 0
PD_kz_ker_128:
  s_branch RB_kz_ker_106
RP_kz_ker_107:
PL_kz_ker_129:
  buffer_load_dwordx2 v[6:7], v3, s[8:11], s42 offen sc1
  s_waitcnt vmcnt(0)
  v_cmp_eq_u64 s[44:45], s[56:57], v[6:7]
  s_andn2_b64 s[62:63], s[52:53], s[44:45]
  s_cmp_eq_u64 s[62:63], 0
  s_cbranch_scc1 PD_kz_ker_130
  s_sub_u32 s60, s60, 1
  s_cbranch_scc0 PL_kz_ker_129
  s_mov_b32 s60, 0
PD_kz_ker_130:
  s_branch RB_kz_ker_108
RP_kz_ker_109:
PL_kz_ker_131:
  buffer_load_dwordx2 v[6:7], v3, s[8:11], s42 offen sc1
  s_waitcnt vmcnt(0)
  v_cmp_eq_u64 s[44:45], s[56:57], v[6:7]
  s_andn2_b64 s[62:63], s[52:53], s[44:45]
  s_cmp_eq_u64 s[62:63], 0
  s_cbranch_scc1 PD_kz_ker_132
  s_sub_u32 s60, s60, 1
  s_cbranch_scc0 PL_kz_ker_131
  s_mov_b32 s60, 0
PD_kz_ker_132:
  s_branch RB_kz_ker_110
RP_kz_ker_111:
PL_kz_ker_133:
  buffer_load_dwordx2 v[6:7], v3, s[8:11], s42 offen sc1
  s_waitcnt vmcnt(0)
  v_cmp_eq_u64 s[44:45], s[56:57], v[6:7]
  s_andn2_b64 s[62:63], s[52:53], s[44:45]
  s_cmp_eq_u64 s[62:63], 0
  s_cbranch_scc1 PD_kz_ker_134
  s_sub_u32 s60, s60, 1
  s_cbranch_scc0 PL_kz_ker_133
  s_mov_b32 s60, 0
PD_kz_ker_134:
  s_branch RB_kz_ker_112
END_kz_ker_2:
kz_kernel_exit:
  s_endpgm
.section .rodata,"a"
.p2align 6
.amdhsa_kernel kz_kernel
  .amdhsa_next_free_vgpr 256
  .amdhsa_next_free_sgpr 64
  .amdhsa_accum_offset 256
  .amdhsa_group_segment_fixed_size 0
  .amdhsa_kernarg_size 80
  .amdhsa_user_sgpr_count 2
  .amdhsa_user_sgpr_kernarg_segment_ptr 1
  .amdhsa_system_sgpr_workgroup_id_x 1
.end_amdhsa_kernel
```
